```python
import torch

def _softmax(x, axis=-1):
    return torch.softmax(x, dim=axis)
def _gelu(x):
    return torch.nn.functional.gelu(x, approximate="tanh")
def _silu(x):
    return torch.nn.functional.silu(x)
def _sigmoid(x):
    return torch.sigmoid(x)
def _layernorm(x, axis=-1, eps=1e-5):
    m = x.mean(dim=axis, keepdim=True)
    v = x.var(dim=axis, keepdim=True, unbiased=False)
    return (x - m) / torch.sqrt(v + eps)
def _scatter_add(tgt, idx, src, axis=0):
    return tgt.clone().index_add_(axis, idx, src)
def _segment_sum(src, seg, n):
    out = torch.zeros((n,) + src.shape[1:], dtype=src.dtype)
    return out.index_add_(0, seg, src)
def _pad(x, pw):
    flat = tuple(v for pair in reversed(pw) for v in pair)
    return torch.nn.functional.pad(x, flat)

kernel_name = 'interleave_layers__sliding_block_cached__mixer_channel_mlp__decode'

def setup_inputs():

    _w = (lambda a: (lambda t: t.to(torch.bfloat16) if t.is_floating_point() else t)(torch.as_tensor(a)))
    def _A_setup():
        B, Sq, D = 8, 1, 640
        Hq, Hkv, Sk, Dh = 32, 32, 4096, 128
        assert Hq % Hkv == 0, (Hq, Hkv)
        return {
            "x": _w((lambda *s: torch.randn(*s, dtype=torch.bfloat16) * 0.05)(B, Sq, D)),
            "k_cache": _w((lambda *s: torch.randn(*s, dtype=torch.bfloat16) * 3.2)(B, Hkv, Sk, Dh)),
            "v_cache": _w((lambda *s: torch.randn(*s, dtype=torch.bfloat16) * 0.4)(B, Hkv, Sk, Dh)),
            "wq": _w((lambda *s: torch.randn(*s, dtype=torch.bfloat16) * 3.2)(D, Hq * Dh) * (D ** -0.5)),
            "wo": _w((lambda *s: torch.randn(*s, dtype=torch.bfloat16) * 0.4)(Hq * Dh, D) * ((Hq * Dh) ** -0.5)),
        }
    _A_in = _A_setup()

    def _B_setup():
        B, S, D, F = 8, 1, 640, 1728
        return {
            "x": _w((lambda *s: torch.randn(*s, dtype=torch.bfloat16) * 0.05)(B, S, D)),
            "w1": _w((lambda *s: torch.randn(*s, dtype=torch.bfloat16) * 1.6)(D, F) * (D ** -0.5)),
            "b1": _w((lambda *s: torch.randn(*s, dtype=torch.bfloat16) * 1.6)(F)),
            "w2": _w((lambda *s: torch.randn(*s, dtype=torch.bfloat16) * 0.1)(F, D) * (F ** -0.5)),
            "b2": _w((lambda *s: torch.randn(*s, dtype=torch.bfloat16) * 0.1)(D)),
        }
    _B_in = _B_setup()

    return {
        "A_x": _A_in["x"],
        "A_k_cache": _A_in["k_cache"],
        "A_v_cache": _A_in["v_cache"],
        "A_wq": _A_in["wq"],
        "A_wo": _A_in["wo"],
        "B_x": _B_in["x"],
        "B_w1": _B_in["w1"],
        "B_b1": _B_in["b1"],
        "B_w2": _B_in["w2"],
        "B_b2": _B_in["b2"],
    }

def reference(A_x, A_k_cache, A_v_cache, A_wq, A_wo, B_x, B_w1, B_b1, B_w2, B_b2):
    def _A_ref(x, k_cache, v_cache, wq, wo):
        B, Sq, D = x.shape
        Hq, Dh = 32, 128
        Hkv, Sk = k_cache.shape[1], k_cache.shape[2]
        W = min(4096, max(256, Sk // 4))
        rep = Hq // Hkv
        q = (lambda x, *d: x.permute(*d))((x @ wq).reshape(B, Sq, Hq, Dh), 0, 2, 1, 3)
        k = (lambda x, n, axis: torch.repeat_interleave(x, n, dim=axis))(k_cache[:, :, Sk - W:, :], rep, axis=1)
        v = (lambda x, n, axis: torch.repeat_interleave(x, n, dim=axis))(v_cache[:, :, Sk - W:, :], rep, axis=1)
        scores = torch.einsum("bhqd,bhkd->bhqk", q, k) * (Dh ** -0.5)
        p = _softmax(scores, axis=-1)
        o = torch.einsum("bhqk,bhkd->bhqd", p, v)
        return (lambda x, *d: x.permute(*d))(o, 0, 2, 1, 3).reshape(B, Sq, Hq * Dh) @ wo

    def _B_ref(x, w1, b1, w2, b2):
        y = _layernorm(x, axis=-1)
        h = _gelu(torch.einsum("bsd,df->bsf", y, w1) + b1)
        return torch.einsum("bsf,fd->bsd", h, w2) + b2

    x = A_x
    x = x + _A_ref(_layernorm(x, axis=-1), A_k_cache, A_v_cache, A_wq, A_wo)
    x = x + _B_ref(_layernorm(x, axis=-1), B_w1, B_b1, B_w2, B_b2)
    x = x + _A_ref(_layernorm(x, axis=-1), A_k_cache, A_v_cache, A_wq, A_wo)
    x = x + _B_ref(_layernorm(x, axis=-1), B_w1, B_b1, B_w2, B_b2)
    return x
```

```asm
; @launch grid=(256,1,1) block=(512,1,1) lds=163840
.amdgcn_target "amdgcn-amd-amdhsa--gfx950"
.text
.globl interleave_layers__sliding_block_cached__mixer_channel_mlp__decode_kernel
.p2align 8
.type interleave_layers__sliding_block_cached__mixer_channel_mlp__decode_kernel,@function
interleave_layers__sliding_block_cached__mixer_channel_mlp__decode_kernel:
  s_cmp_ge_u32 s2, 256
  s_cbranch_scc1 L_end
  s_load_dwordx2 s[4:5], s[0:1], 0
  s_load_dwordx4 s[36:39], s[0:1], 8
  s_load_dwordx4 s[40:43], s[0:1], 24
  s_load_dwordx4 s[68:71], s[0:1], 48
  s_load_dwordx4 s[72:75], s[0:1], 64
  s_load_dwordx4 s[60:63], s[0:1], 80
  s_load_dwordx2 s[64:65], s[0:1], 96
  s_and_b32 s44, s2, 7
  s_lshr_b32 s45, s2, 3
  s_and_b32 s46, s45, 3
  s_lshl_b32 s56, s44, 2
  s_add_u32 s46, s46, s56
  s_lshr_b32 s47, s45, 2
  s_lshl_b32 s56, s47, 5
  s_add_u32 s56, s56, s46
  s_lshl_b32 s56, s56, 20
  s_add_u32 s56, s56, 0xC0000
  v_lshrrev_b32 v1, 6, v0
  v_and_b32 v2, 63, v0
  v_readfirstlane_b32 s48, v1
  s_mov_b32 s52, 0
  s_mov_b32 s53, 0
  s_waitcnt lgkmcnt(0)
  s_add_u32 s16, s36, s56
  s_addc_u32 s17, s37, 0
  s_mov_b32 s18, 0x40000
  s_mov_b32 s19, 0x20000
  s_add_u32 s20, s38, s56
  s_addc_u32 s21, s39, 0
  s_mov_b32 s22, 0x40000
  s_mov_b32 s23, 0x20000
  s_add_u32 s24, s64, 0x1fffff
  s_addc_u32 s25, s65, 0
  s_and_b32 s24, s24, 0xffe00000
  s_mov_b32 s26, 2097152
  s_mov_b32 s27, 0x20000
  s_mov_b64 s[28:29], s[62:63]
  s_mov_b32 s30, 256
  s_mov_b32 s31, 0x20000
  s_mov_b64 s[32:33], s[60:61]
  s_mov_b32 s34, 10240
  s_mov_b32 s35, 0x20000
  s_mov_b64 s[6:7], s[40:41]
  s_mov_b64 s[8:9], s[42:43]
  s_mov_b64 s[10:11], s[68:69]
  s_mov_b64 s[12:13], s[70:71]
  s_mov_b64 s[14:15], s[72:73]
  s_mov_b64 s[0:1], s[74:75]
  s_mov_b32 s66, 0
  s_mov_b32 s67, 4096
  s_mov_b32 s68, 8192
  s_mov_b32 s69, 12288
  s_mov_b32 s70, 16384
  s_mov_b32 s71, 20480
  s_mov_b32 s72, 24576
  s_mov_b32 s73, 28672
  s_mul_i32 s74, s48, 18432
  s_add_u32 s74, s74, 16384
  s_cmp_lt_u32 s44, 3
  s_cselect_b32 s55, 4, 3
  s_lshl_b32 s64, s44, 2
  s_mul_i32 s56, s44, 3
  s_add_u32 s56, s56, 3
  s_min_u32 s64, s64, s56
  s_mov_b32 s49, 1
  s_mov_b32 s50, s45
  s_sub_u32 s56, s45, 8
  s_cmp_ge_u32 s45, 8
  s_cselect_b32 s49, 2, s49
  s_cselect_b32 s50, s56, s50
  s_sub_u32 s56, s45, 18
  s_cmp_ge_u32 s45, 18
  s_cselect_b32 s49, 4, s49
  s_cselect_b32 s50, s56, s50
  s_sub_u32 s56, s45, 28
  s_cmp_ge_u32 s45, 28
  s_cselect_b32 s49, 3, s49
  s_cselect_b32 s50, s56, s50
  s_cmp_lg_u32 s49, 3
  s_cbranch_scc1 RN_1
  s_cmp_ge_u32 s50, s55
  s_cselect_b32 s49, 0, s49
RN_1:
  s_mov_b32 s39, 0x20000
  s_mov_b32 s43, 0x20000
  s_and_b32 s56, s49, 3
  s_cmp_eq_u32 s56, 0
  s_cselect_b32 s100, 1, 0
  s_cmp_eq_u32 s48, 7
  s_cbranch_scc1 W7_2
  v_lshrrev_b32 v3, 3, v2
  s_lshl_b32 s56, s48, 3
  v_add_u32 v3, s56, v3
  v_and_b32 v4, 7, v2
  v_bfe_u32 v6, v2, 4, 1
  v_xor_b32 v4, v4, v6
  s_and_b32 s56, s48, 1
  s_lshl_b32 s56, s56, 1
  v_xor_b32 v4, s56, v4
  v_lshlrev_b32 v4, 4, v4
  s_cmp_eq_u32 s49, 0
  s_cbranch_scc1 SM_3
  s_cmp_eq_u32 s49, 2
  s_cbranch_scc1 D2_4
  s_cmp_eq_u32 s49, 3
  s_cbranch_scc1 D3_5
  s_cmp_eq_u32 s49, 4
  s_cbranch_scc1 D4_6
  s_mov_b64 s[36:37], s[6:7]
  s_mov_b32 s38, 5242880
  s_lshl_b32 s58, s44, 10
  s_lshl_b32 s59, s50, 7
  s_add_u32 s58, s58, s59
  v_mul_u32_u24 v5, 8192, v3
  v_add3_u32 v5, v5, v4, s58
  s_lshl_b32 s59, s48, 10
  s_add_u32 s56, s48, 0
  s_cmp_ge_u32 s56, 40
  s_cselect_b32 s56, 64, 0
  v_xor_b32 v6, s56, v5
  s_add_u32 m0, s59, 81920
  s_mov_b32 s58, 0
  buffer_load_dwordx4 v6, s[36:39], s58 offen nt lds
  s_add_u32 s56, s48, 7
  s_cmp_ge_u32 s56, 40
  s_cselect_b32 s56, 96, 32
  v_xor_b32 v6, s56, v5
  s_add_u32 m0, s59, 89088
  s_mov_b32 s58, 458752
  buffer_load_dwordx4 v6, s[36:39], s58 offen nt lds
  s_add_u32 s56, s48, 14
  s_cmp_ge_u32 s56, 40
  s_cselect_b32 s56, 64, 0
  v_xor_b32 v6, s56, v5
  s_add_u32 m0, s59, 96256
  s_mov_b32 s58, 917504
  buffer_load_dwordx4 v6, s[36:39], s58 offen nt lds
  s_add_u32 s56, s48, 21
  s_cmp_ge_u32 s56, 40
  s_cselect_b32 s56, 96, 32
  v_xor_b32 v6, s56, v5
  s_add_u32 m0, s59, 103424
  s_mov_b32 s58, 1376256
  buffer_load_dwordx4 v6, s[36:39], s58 offen nt lds
  s_add_u32 s56, s48, 28
  s_cmp_ge_u32 s56, 40
  s_cselect_b32 s56, 64, 0
  v_xor_b32 v6, s56, v5
  s_add_u32 m0, s59, 110592
  s_mov_b32 s58, 1835008
  buffer_load_dwordx4 v6, s[36:39], s58 offen nt lds
  s_add_u32 s56, s48, 35
  s_cmp_ge_u32 s56, 40
  s_cselect_b32 s56, 96, 32
  v_xor_b32 v6, s56, v5
  s_add_u32 m0, s59, 117760
  s_mov_b32 s58, 2293760
  buffer_load_dwordx4 v6, s[36:39], s58 offen nt lds
  s_add_u32 s56, s48, 42
  s_cmp_ge_u32 s56, 40
  s_cselect_b32 s56, 64, 0
  v_xor_b32 v6, s56, v5
  s_add_u32 m0, s59, 124928
  s_mov_b32 s58, 2752512
  buffer_load_dwordx4 v6, s[36:39], s58 offen nt lds
  s_add_u32 s56, s48, 49
  s_cmp_ge_u32 s56, 40
  s_cselect_b32 s56, 96, 32
  v_xor_b32 v6, s56, v5
  s_add_u32 m0, s59, 132096
  s_mov_b32 s58, 3211264
  buffer_load_dwordx4 v6, s[36:39], s58 offen nt lds
  s_add_u32 s56, s48, 56
  s_cmp_ge_u32 s56, 40
  s_cselect_b32 s56, 64, 0
  v_xor_b32 v6, s56, v5
  s_add_u32 m0, s59, 139264
  s_mov_b32 s58, 3670016
  buffer_load_dwordx4 v6, s[36:39], s58 offen nt lds
  s_add_u32 s56, s48, 63
  s_cmp_ge_u32 s56, 40
  s_cselect_b32 s56, 96, 32
  v_xor_b32 v6, s56, v5
  s_add_u32 m0, s59, 146432
  s_mov_b32 s58, 4128768
  buffer_load_dwordx4 v6, s[36:39], s58 offen nt lds
  s_add_u32 s56, s48, 70
  s_cmp_ge_u32 s56, 40
  s_cselect_b32 s56, 64, 0
  v_xor_b32 v6, s56, v5
  s_add_u32 m0, s59, 153600
  s_mov_b32 s58, 4587520
  buffer_load_dwordx4 v6, s[36:39], s58 offen nt lds
  s_cmp_ge_u32 s48, 3
  s_cbranch_scc1 SM_3
  s_add_u32 s56, s48, 77
  s_cmp_ge_u32 s56, 40
  s_cselect_b32 s56, 96, 32
  v_xor_b32 v6, s56, v5
  s_add_u32 m0, s59, 160768
  s_mov_b32 s58, 5046272
  buffer_load_dwordx4 v6, s[36:39], s58 offen nt lds
  s_branch SM_3
D2_4:
  s_mov_b64 s[36:37], s[8:9]
  s_mov_b32 s38, 5242880
  s_mul_i32 s58, s44, 655360
  s_lshl_b32 s59, s50, 7
  s_add_u32 s58, s58, s59
  v_mul_u32_u24 v5, 1280, v3
  v_add3_u32 v5, v5, v4, s58
  s_lshl_b32 s59, s48, 10
  s_add_u32 s56, s48, 0
  s_cmp_ge_u32 s56, 32
  s_cselect_b32 s56, 64, 0
  v_xor_b32 v6, s56, v5
  s_add_u32 m0, s59, 81920
  s_mov_b32 s58, 0
  buffer_load_dwordx4 v6, s[36:39], s58 offen nt lds
  s_add_u32 s56, s48, 7
  s_cmp_ge_u32 s56, 32
  s_cselect_b32 s56, 96, 32
  v_xor_b32 v6, s56, v5
  s_add_u32 m0, s59, 89088
  s_mov_b32 s58, 71680
  buffer_load_dwordx4 v6, s[36:39], s58 offen nt lds
  s_add_u32 s56, s48, 14
  s_cmp_ge_u32 s56, 32
  s_cselect_b32 s56, 64, 0
  v_xor_b32 v6, s56, v5
  s_add_u32 m0, s59, 96256
  s_mov_b32 s58, 143360
  buffer_load_dwordx4 v6, s[36:39], s58 offen nt lds
  s_add_u32 s56, s48, 21
  s_cmp_ge_u32 s56, 32
  s_cselect_b32 s56, 96, 32
  v_xor_b32 v6, s56, v5
  s_add_u32 m0, s59, 103424
  s_mov_b32 s58, 215040
  buffer_load_dwordx4 v6, s[36:39], s58 offen nt lds
  s_add_u32 s56, s48, 28
  s_cmp_ge_u32 s56, 32
  s_cselect_b32 s56, 64, 0
  v_xor_b32 v6, s56, v5
  s_add_u32 m0, s59, 110592
  s_mov_b32 s58, 286720
  buffer_load_dwordx4 v6, s[36:39], s58 offen nt lds
  s_add_u32 s56, s48, 35
  s_cmp_ge_u32 s56, 32
  s_cselect_b32 s56, 96, 32
  v_xor_b32 v6, s56, v5
  s_add_u32 m0, s59, 117760
  s_mov_b32 s58, 358400
  buffer_load_dwordx4 v6, s[36:39], s58 offen nt lds
  s_add_u32 s56, s48, 42
  s_cmp_ge_u32 s56, 32
  s_cselect_b32 s56, 64, 0
  v_xor_b32 v6, s56, v5
  s_add_u32 m0, s59, 124928
  s_mov_b32 s58, 430080
  buffer_load_dwordx4 v6, s[36:39], s58 offen nt lds
  s_add_u32 s56, s48, 49
  s_cmp_ge_u32 s56, 32
  s_cselect_b32 s56, 96, 32
  v_xor_b32 v6, s56, v5
  s_add_u32 m0, s59, 132096
  s_mov_b32 s58, 501760
  buffer_load_dwordx4 v6, s[36:39], s58 offen nt lds
  s_add_u32 s56, s48, 56
  s_cmp_ge_u32 s56, 32
  s_cselect_b32 s56, 64, 0
  v_xor_b32 v6, s56, v5
  s_add_u32 m0, s59, 139264
  s_mov_b32 s58, 573440
  buffer_load_dwordx4 v6, s[36:39], s58 offen nt lds
  s_cmp_ge_u32 s48, 1
  s_cbranch_scc1 SM_3
  s_add_u32 s56, s48, 63
  s_cmp_ge_u32 s56, 32
  s_cselect_b32 s56, 96, 32
  v_xor_b32 v6, s56, v5
  s_add_u32 m0, s59, 146432
  s_mov_b32 s58, 645120
  buffer_load_dwordx4 v6, s[36:39], s58 offen nt lds
  s_branch SM_3
D3_5:
  s_mov_b64 s[36:37], s[10:11]
  s_mov_b32 s38, 2211840
  s_add_u32 s58, s64, s50
  s_lshl_b32 s58, s58, 7
  v_mul_u32_u24 v5, 3456, v3
  v_add3_u32 v5, v5, v4, s58
  s_lshl_b32 s59, s48, 10
  s_add_u32 s56, s48, 0
  s_cmp_ge_u32 s56, 40
  s_cselect_b32 s56, 64, 0
  v_xor_b32 v6, s56, v5
  s_add_u32 m0, s59, 81920
  s_mov_b32 s58, 0
  buffer_load_dwordx4 v6, s[36:39], s58 offen nt lds
  s_add_u32 s56, s48, 7
  s_cmp_ge_u32 s56, 40
  s_cselect_b32 s56, 96, 32
  v_xor_b32 v6, s56, v5
  s_add_u32 m0, s59, 89088
  s_mov_b32 s58, 193536
  buffer_load_dwordx4 v6, s[36:39], s58 offen nt lds
  s_add_u32 s56, s48, 14
  s_cmp_ge_u32 s56, 40
  s_cselect_b32 s56, 64, 0
  v_xor_b32 v6, s56, v5
  s_add_u32 m0, s59, 96256
  s_mov_b32 s58, 387072
  buffer_load_dwordx4 v6, s[36:39], s58 offen nt lds
  s_add_u32 s56, s48, 21
  s_cmp_ge_u32 s56, 40
  s_cselect_b32 s56, 96, 32
  v_xor_b32 v6, s56, v5
  s_add_u32 m0, s59, 103424
  s_mov_b32 s58, 580608
  buffer_load_dwordx4 v6, s[36:39], s58 offen nt lds
  s_add_u32 s56, s48, 28
  s_cmp_ge_u32 s56, 40
  s_cselect_b32 s56, 64, 0
  v_xor_b32 v6, s56, v5
  s_add_u32 m0, s59, 110592
  s_mov_b32 s58, 774144
  buffer_load_dwordx4 v6, s[36:39], s58 offen nt lds
  s_add_u32 s56, s48, 35
  s_cmp_ge_u32 s56, 40
  s_cselect_b32 s56, 96, 32
  v_xor_b32 v6, s56, v5
  s_add_u32 m0, s59, 117760
  s_mov_b32 s58, 967680
  buffer_load_dwordx4 v6, s[36:39], s58 offen nt lds
  s_add_u32 s56, s48, 42
  s_cmp_ge_u32 s56, 40
  s_cselect_b32 s56, 64, 0
  v_xor_b32 v6, s56, v5
  s_add_u32 m0, s59, 124928
  s_mov_b32 s58, 1161216
  buffer_load_dwordx4 v6, s[36:39], s58 offen nt lds
  s_add_u32 s56, s48, 49
  s_cmp_ge_u32 s56, 40
  s_cselect_b32 s56, 96, 32
  v_xor_b32 v6, s56, v5
  s_add_u32 m0, s59, 132096
  s_mov_b32 s58, 1354752
  buffer_load_dwordx4 v6, s[36:39], s58 offen nt lds
  s_add_u32 s56, s48, 56
  s_cmp_ge_u32 s56, 40
  s_cselect_b32 s56, 64, 0
  v_xor_b32 v6, s56, v5
  s_add_u32 m0, s59, 139264
  s_mov_b32 s58, 1548288
  buffer_load_dwordx4 v6, s[36:39], s58 offen nt lds
  s_add_u32 s56, s48, 63
  s_cmp_ge_u32 s56, 40
  s_cselect_b32 s56, 96, 32
  v_xor_b32 v6, s56, v5
  s_add_u32 m0, s59, 146432
  s_mov_b32 s58, 1741824
  buffer_load_dwordx4 v6, s[36:39], s58 offen nt lds
  s_add_u32 s56, s48, 70
  s_cmp_ge_u32 s56, 40
  s_cselect_b32 s56, 64, 0
  v_xor_b32 v6, s56, v5
  s_add_u32 m0, s59, 153600
  s_mov_b32 s58, 1935360
  buffer_load_dwordx4 v6, s[36:39], s58 offen nt lds
  s_cmp_ge_u32 s48, 3
  s_cbranch_scc1 SM_3
  s_add_u32 s56, s48, 77
  s_cmp_ge_u32 s56, 40
  s_cselect_b32 s56, 96, 32
  v_xor_b32 v6, s56, v5
  s_add_u32 m0, s59, 160768
  s_mov_b32 s58, 2128896
  buffer_load_dwordx4 v6, s[36:39], s58 offen nt lds
  s_branch SM_3
D4_6:
  s_mov_b64 s[36:37], s[14:15]
  s_mov_b32 s38, 2211840
  s_mul_i32 s58, s64, 81920
  s_lshl_b32 s59, s50, 7
  s_add_u32 s58, s58, s59
  s_lshl_b32 s76, s55, 3
  s_lshl_b32 s77, s55, 2
  v_mul_u32_u24 v5, 1280, v3
  v_add3_u32 v5, v5, v4, s58
  s_lshl_b32 s59, s48, 10
  s_add_u32 s56, s48, 0
  s_cmp_ge_u32 s56, s77
  s_cselect_b32 s56, 64, 0
  v_xor_b32 v6, s56, v5
  s_add_u32 m0, s59, 81920
  s_mov_b32 s58, 0
  buffer_load_dwordx4 v6, s[36:39], s58 offen nt lds
  s_add_u32 s56, s48, 7
  s_cmp_ge_u32 s56, s77
  s_cselect_b32 s56, 96, 32
  v_xor_b32 v6, s56, v5
  s_add_u32 m0, s59, 89088
  s_mov_b32 s58, 71680
  buffer_load_dwordx4 v6, s[36:39], s58 offen nt lds
  s_add_u32 s56, s48, 14
  s_cmp_ge_u32 s56, s77
  s_cselect_b32 s56, 64, 0
  v_xor_b32 v6, s56, v5
  s_add_u32 m0, s59, 96256
  s_mov_b32 s58, 143360
  buffer_load_dwordx4 v6, s[36:39], s58 offen nt lds
  s_add_u32 s56, s48, 21
  s_cmp_ge_u32 s56, s76
  s_cbranch_scc1 SM_3
  s_add_u32 s56, s48, 21
  s_cmp_ge_u32 s56, s77
  s_cselect_b32 s56, 96, 32
  v_xor_b32 v6, s56, v5
  s_add_u32 m0, s59, 103424
  s_mov_b32 s58, 215040
  buffer_load_dwordx4 v6, s[36:39], s58 offen nt lds
  s_add_u32 s56, s48, 28
  s_cmp_ge_u32 s56, s76
  s_cbranch_scc1 SM_3
  s_add_u32 s56, s48, 28
  s_cmp_ge_u32 s56, s77
  s_cselect_b32 s56, 64, 0
  v_xor_b32 v6, s56, v5
  s_add_u32 m0, s59, 110592
  s_mov_b32 s58, 286720
  buffer_load_dwordx4 v6, s[36:39], s58 offen nt lds
  s_branch SM_3
W7_2:
  v_mov_b32 v4, -1
  v_mov_b32 v5, -1
  v_mov_b32 v6, -1
  v_mov_b32 v7, -1
  v_lshlrev_b32 v3, 4, v2
  s_cmp_lg_u32 s49, 1
  s_cbranch_scc1 CQ0_7
  s_lshl_b32 s3, s44, 3
  s_add_u32 s3, s3, s50
  s_lshl_b32 s3, s3, 10
  s_add_u32 s3, s3, 589824
  buffer_store_dwordx4 v[4:7], v3, s[24:27], s3 offen sc1
CQ0_7:
  s_mul_i32 s3, s2, 2304
  buffer_store_dwordx4 v[4:7], v3, s[24:27], s3 offen sc1
  buffer_store_dwordx4 v[4:7], v3, s[24:27], s3 offen offset:1024 sc1
  s_mov_b64 exec, 0xffff
  buffer_store_dwordx4 v[4:7], v3, s[24:27], s3 offen offset:2048 sc1
  s_lshl_b32 s3, s2, 8
  s_add_u32 s3, s3, 1572864
  buffer_store_dwordx4 v[4:7], v3, s[24:27], s3 offen sc1
  s_mov_b64 exec, -1
  s_getreg_b32 s56, hwreg(HW_REG_XCC_ID)
  s_and_b32 s56, s56, 7
  s_mul_i32 s57, s56, s56
  s_lshl_b32 s57, s57, 6
  s_lshl_b32 s56, s56, 17
  s_or_b32 s56, s56, s57
  s_or_b32 s56, s56, 33554432
  s_lshl_b32 s57, s44, 2
  v_mov_b32 v8, s56
  v_mov_b32 v9, s57
  s_waitcnt vmcnt(0)
  s_mov_b64 exec, 1
  buffer_atomic_add v8, v9, s[28:31], 0 offen sc1
  s_mov_b64 exec, -1
SM_3:
  s_mov_b64 s[36:37], s[4:5]
  s_mov_b32 s38, 10240
  s_cmp_eq_u32 s49, 4
  s_cbranch_scc1 SR_9
  s_cmp_eq_u32 s49, 3
  s_cbranch_scc1 SMM_10
  s_cmp_lg_u32 s49, 1
  s_cbranch_scc1 SEnd_11
  s_mul_i32 s56, s48, 1280
  v_lshlrev_b32 v5, 2, v2
  buffer_load_dword v10, v5, s[36:39], s56 offen offset:0
  buffer_load_dword v11, v5, s[36:39], s56 offen offset:256
  buffer_load_dword v12, v5, s[36:39], s56 offen offset:512
  buffer_load_dword v13, v5, s[36:39], s56 offen offset:768
  buffer_load_dword v14, v5, s[36:39], s56 offen offset:1024
  s_branch SEnd_11
SR_9:
  v_lshrrev_b32 v5, 3, v2
  v_and_b32 v6, 7, v2
  s_lshl_b32 s56, s50, 3
  s_add_u32 s56, s56, s48
  s_lshl_b32 s56, s56, 4
  v_lshlrev_b32 v6, 1, v6
  v_mul_u32_u24 v5, 1280, v5
  v_add_u32 v5, v5, v6
  buffer_load_ushort v248, v5, s[36:39], s56 offen
  s_mov_b64 s[40:41], s[0:1]
  s_mov_b32 s42, 1280
  buffer_load_ushort v249, v6, s[40:43], s56 offen
  s_branch SEnd_11
SMM_10:
  s_mov_b64 s[40:41], s[12:13]
  s_mov_b32 s42, 3456
  s_add_u32 s56, s64, s50
  s_lshl_b32 s56, s56, 7
  v_lshlrev_b32 v6, 1, v2
  buffer_load_ushort v15, v6, s[40:43], s56 offen
SEnd_11:
  s_mov_b32 s4, 0x3f803f80
  s_mov_b32 s5, 0x00003f80
  s_mov_b32 s6, 0x3f800000
  v_mbcnt_lo_u32_b32 v29, -1, 0
  v_mbcnt_hi_u32_b32 v29, -1, v29
  s_lshl_b32 s56, s48, 15
  v_and_b32 v30, 7, v29
  v_lshlrev_b32 v30, 8, v30
  v_bfe_u32 v31, v29, 3, 1
  v_lshl_add_u32 v30, v31, 6, v30
  v_lshrrev_b32 v31, 4, v29
  v_lshl_add_u32 v30, v31, 4, v30
  v_add_u32 v30, s56, v30
  v_and_b32 v31, 15, v29
  v_lshlrev_b32 v31, 4, v31
  v_add_u32 v31, s56, v31
  v_bfe_u32 v28, v29, 4, 1
  v_lshl_add_u32 v31, v28, 14, v31
  v_lshrrev_b32 v28, 5, v29
  v_lshl_add_u32 v31, v28, 11, v31
  buffer_load_dwordx4 v[32:35], v30, s[16:19], s66 offen offset:0 nt
  buffer_load_dwordx4 v[36:39], v30, s[16:19], s66 offen offset:128 nt
  buffer_load_dwordx4 v[40:43], v30, s[16:19], s66 offen offset:2048 nt
  buffer_load_dwordx4 v[44:47], v30, s[16:19], s66 offen offset:2176 nt
  buffer_load_dwordx4 v[48:51], v30, s[16:19], s67 offen offset:0 nt
  s_cmp_lg_u32 s48, 7
  s_cbranch_scc1 PRB_12
  s_cmp_lg_u32 s49, 4
  s_cbranch_scc1 PRB_12
  s_and_b32 s3, s2, 63
  s_lshl_b32 s3, s3, 7
  s_lshr_b32 s56, s2, 6
  s_lshl_b32 s56, s56, 14
  s_add_u32 s3, s3, s56
  s_add_u32 s3, s3, 0x1E0000
  s_add_u32 s60, s24, s3
  s_addc_u32 s61, s25, 0
  s_load_dword s56, s[60:61], 0 glc
  s_load_dword s57, s[60:61], 0x2000 glc
  s_waitcnt lgkmcnt(0)
  s_mov_b32 s76, 0
  s_memtime s[62:63]
  s_waitcnt lgkmcnt(0)
  s_load_dword s56, s[60:61], 0 glc
  s_waitcnt lgkmcnt(0)
  s_memtime s[58:59]
  s_waitcnt lgkmcnt(0)
  s_load_dword s56, s[60:61], 0x2000 glc
  s_waitcnt lgkmcnt(0)
  s_memtime s[56:57]
  s_waitcnt lgkmcnt(0)
  s_lshl_b32 s58, s58, 1
  s_sub_u32 s58, s58, s62
  s_sub_u32 s58, s58, s56
  s_add_u32 s76, s76, s58
  s_memtime s[62:63]
  s_waitcnt lgkmcnt(0)
  s_load_dword s56, s[60:61], 0 glc
  s_waitcnt lgkmcnt(0)
  s_memtime s[58:59]
  s_waitcnt lgkmcnt(0)
  s_load_dword s56, s[60:61], 0x2000 glc
  s_waitcnt lgkmcnt(0)
  s_memtime s[56:57]
  s_waitcnt lgkmcnt(0)
  s_lshl_b32 s58, s58, 1
  s_sub_u32 s58, s58, s62
  s_sub_u32 s58, s58, s56
  s_add_u32 s76, s76, s58
  s_lshr_b32 s76, s76, 31
  s_getreg_b32 s56, hwreg(HW_REG_XCC_ID)
  s_and_b32 s56, s56, 7
  s_lshr_b32 s77, s56, 2
  s_xor_b32 s76, s76, s77
  s_or_b32 s76, s76, 0x10000
  v_mov_b32 v8, s76
  v_mov_b32 v9, 128
  s_mov_b64 exec, 1
  buffer_atomic_add v8, v9, s[28:31], 0 offen sc1
  s_mov_b64 exec, -1
PRB_12:
  buffer_load_dwordx4 v[52:55], v30, s[16:19], s67 offen offset:128 nt
  s_waitcnt vmcnt(6)
  s_waitcnt lgkmcnt(0)
  s_barrier
  v_mbcnt_lo_u32_b32 v2, -1, 0
  v_mbcnt_hi_u32_b32 v2, -1, v2
  s_cmp_eq_u32 s49, 0
  s_cbranch_scc1 TR_13
  s_mov_b32 s56, 320
  s_cmp_eq_u32 s49, 2
  s_cselect_b32 s56, 256, s56
  s_lshl_b32 s57, s55, 5
  s_cmp_eq_u32 s49, 4
  s_cselect_b32 s56, s57, s56
  v_and_b32 v3, 3, v2
  v_bfe_u32 v4, v2, 2, 2
  v_lshrrev_b32 v5, 4, v2
  v_lshrrev_b32 v6, 1, v3
  v_lshrrev_b32 v7, 1, v4
  v_and_b32 v8, 1, v5
  v_lshl_or_b32 v7, v8, 1, v7
  v_lshl_or_b32 v7, v6, 2, v7
  v_xor_b32 v7, s48, v7
  v_mul_u32_u24 v6, s56, v6
  v_lshl_add_u32 v6, v5, 3, v6
  v_add_u32 v6, v6, v4
  v_and_b32 v3, 1, v3
  v_lshlrev_b32 v3, 3, v3
  v_lshl_add_u32 v6, v6, 7, v3
  v_lshl_add_u32 v6, v7, 4, v6
  v_add_u32 v6, 81920, v6
  ds_read_b64_tr_b16 v[216:217], v6 offset:0
  ds_read_b64_tr_b16 v[218:219], v6 offset:512
  ds_read_b64_tr_b16 v[220:221], v6 offset:4096
  ds_read_b64_tr_b16 v[222:223], v6 offset:4608
  ds_read_b64_tr_b16 v[224:225], v6 offset:8192
  ds_read_b64_tr_b16 v[226:227], v6 offset:8704
  ds_read_b64_tr_b16 v[228:229], v6 offset:12288
  ds_read_b64_tr_b16 v[230:231], v6 offset:12800
  s_cmp_eq_u32 s49, 4
  s_cbranch_scc1 TR_13
  ds_read_b64_tr_b16 v[232:233], v6 offset:16384
  ds_read_b64_tr_b16 v[234:235], v6 offset:16896
  ds_read_b64_tr_b16 v[236:237], v6 offset:20480
  ds_read_b64_tr_b16 v[238:239], v6 offset:20992
  ds_read_b64_tr_b16 v[240:241], v6 offset:24576
  ds_read_b64_tr_b16 v[242:243], v6 offset:25088
  ds_read_b64_tr_b16 v[244:245], v6 offset:28672
  ds_read_b64_tr_b16 v[246:247], v6 offset:29184
  s_cmp_eq_u32 s49, 2
  s_cbranch_scc1 TR_13
  ds_read_b64_tr_b16 v[248:249], v6 offset:32768
  ds_read_b64_tr_b16 v[250:251], v6 offset:33280
  ds_read_b64_tr_b16 v[252:253], v6 offset:36864
  ds_read_b64_tr_b16 v[254:255], v6 offset:37376
TR_13:
  s_waitcnt lgkmcnt(0)
  buffer_load_dwordx4 v[56:59], v30, s[16:19], s67 offen offset:2048 nt
  buffer_load_dwordx4 v[60:63], v30, s[16:19], s67 offen offset:2176 nt
  buffer_load_dwordx4 v[64:67], v30, s[16:19], s68 offen offset:0 nt
  buffer_load_dwordx4 v[68:71], v30, s[16:19], s68 offen offset:128 nt
  s_cmp_eq_u32 s49, 4
  s_cbranch_scc1 T4_14
  s_cmp_eq_u32 s49, 3
  s_cbranch_scc1 T3_15
  s_cmp_lg_u32 s49, 1
  s_cbranch_scc1 TE_16
  v_readfirstlane_b32 s56, v10
  s_lshl_b32 s56, s56, 16
  s_xor_b32 s57, s56, 0x80000000
  v_mov_b32 v4, s57
  v_dot2_f32_bf16 v16, v10, s5, v4
  v_dot2_f32_bf16 v17, v10, s6, v4
  v_dot2_f32_bf16 v18, v11, s5, v4
  v_dot2_f32_bf16 v19, v11, s6, v4
  v_dot2_f32_bf16 v20, v12, s5, v4
  v_dot2_f32_bf16 v21, v12, s6, v4
  v_dot2_f32_bf16 v22, v13, s5, v4
  v_dot2_f32_bf16 v23, v13, s6, v4
  v_dot2_f32_bf16 v24, v14, s5, v4
  v_dot2_f32_bf16 v25, v14, s6, v4
  v_pk_add_f32 v[0:1], v[16:17], v[18:19]
  v_pk_mul_f32 v[2:3], v[16:17], v[16:17]
  v_pk_fma_f32 v[2:3], v[18:19], v[18:19], v[2:3]
  v_pk_add_f32 v[0:1], v[20:21], v[0:1]
  v_pk_fma_f32 v[2:3], v[20:21], v[20:21], v[2:3]
  v_pk_add_f32 v[0:1], v[22:23], v[0:1]
  v_pk_fma_f32 v[2:3], v[22:23], v[22:23], v[2:3]
  v_pk_add_f32 v[0:1], v[24:25], v[0:1]
  v_pk_fma_f32 v[2:3], v[24:25], v[24:25], v[2:3]
  v_add_f32 v0, v0, v1
  v_add_f32 v2, v2, v3
  s_nop 0
  v_add_f32_dpp v0, v0, v0 row_shr:1 row_mask:0xf bank_mask:0xf
  v_add_f32_dpp v2, v2, v2 row_shr:1 row_mask:0xf bank_mask:0xf
  s_nop 0
  v_add_f32_dpp v0, v0, v0 row_shr:2 row_mask:0xf bank_mask:0xf
  v_add_f32_dpp v2, v2, v2 row_shr:2 row_mask:0xf bank_mask:0xf
  s_nop 0
  v_add_f32_dpp v0, v0, v0 row_shr:4 row_mask:0xf bank_mask:0xf
  v_add_f32_dpp v2, v2, v2 row_shr:4 row_mask:0xf bank_mask:0xf
  s_nop 0
  v_add_f32_dpp v0, v0, v0 row_shr:8 row_mask:0xf bank_mask:0xf
  v_add_f32_dpp v2, v2, v2 row_shr:8 row_mask:0xf bank_mask:0xf
  s_nop 0
  v_add_f32_dpp v0, v0, v0 row_bcast:15 row_mask:0xa bank_mask:0xf
  v_add_f32_dpp v2, v2, v2 row_bcast:15 row_mask:0xa bank_mask:0xf
  s_nop 0
  v_add_f32_dpp v0, v0, v0 row_bcast:31 row_mask:0xc bank_mask:0xf
  v_add_f32_dpp v2, v2, v2 row_bcast:31 row_mask:0xc bank_mask:0xf
  s_nop 1
  v_readlane_b32 s57, v0, 63
  v_readlane_b32 s58, v2, 63
  v_mov_b32 v4, 0x3acccccd
  s_nop 0
  v_mul_f32 v0, s57, v4
  v_mul_f32 v2, s58, v4
  v_fma_f32 v2, -v0, v0, v2
  v_add_f32 v0, s56, v0
  v_max_f32 v2, 0, v2
  v_cvt_pk_bf16_f32 v4, v0, v2
  v_and_b32 v2, 0xffff0000, v4
  v_add_f32 v2, 0x37280000, v2
  v_lshlrev_b32 v0, 16, v4
  v_cvt_pk_bf16_f32 v2, v2, v2
  v_and_b32 v2, 0xffff0000, v2
  v_sqrt_f32 v2, v2
  v_sub_f32 v0, s56, v0
  v_cvt_pk_bf16_f32 v2, v2, v2
  v_and_b32 v2, 0xffff0000, v2
  v_rcp_f32 v2, v2
  v_pk_add_f32 v[16:17], v[16:17], v[0:1] op_sel_hi:[1,0]
  v_pk_add_f32 v[18:19], v[18:19], v[0:1] op_sel_hi:[1,0]
  v_pk_add_f32 v[20:21], v[20:21], v[0:1] op_sel_hi:[1,0]
  v_pk_add_f32 v[22:23], v[22:23], v[0:1] op_sel_hi:[1,0]
  v_pk_add_f32 v[24:25], v[24:25], v[0:1] op_sel_hi:[1,0]
  v_cvt_pk_bf16_f32 v10, v16, v17
  v_cvt_pk_bf16_f32 v11, v18, v19
  v_cvt_pk_bf16_f32 v12, v20, v21
  v_cvt_pk_bf16_f32 v13, v22, v23
  v_cvt_pk_bf16_f32 v14, v24, v25
  v_lshlrev_b32 v16, 16, v10
  v_and_b32 v17, 0xffff0000, v10
  v_lshlrev_b32 v18, 16, v11
  v_and_b32 v19, 0xffff0000, v11
  v_lshlrev_b32 v20, 16, v12
  v_and_b32 v21, 0xffff0000, v12
  v_lshlrev_b32 v22, 16, v13
  v_and_b32 v23, 0xffff0000, v13
  v_lshlrev_b32 v24, 16, v14
  v_and_b32 v25, 0xffff0000, v14
  v_pk_mul_f32 v[16:17], v[16:17], v[2:3] op_sel_hi:[1,0]
  v_pk_mul_f32 v[18:19], v[18:19], v[2:3] op_sel_hi:[1,0]
  v_pk_mul_f32 v[20:21], v[20:21], v[2:3] op_sel_hi:[1,0]
  v_pk_mul_f32 v[22:23], v[22:23], v[2:3] op_sel_hi:[1,0]
  v_pk_mul_f32 v[24:25], v[24:25], v[2:3] op_sel_hi:[1,0]
  v_cvt_pk_bf16_f32 v10, v16, v17
  v_cvt_pk_bf16_f32 v11, v18, v19
  v_cvt_pk_bf16_f32 v12, v20, v21
  v_cvt_pk_bf16_f32 v13, v22, v23
  v_cvt_pk_bf16_f32 v14, v24, v25
  v_mbcnt_lo_u32_b32 v2, -1, 0
  v_mbcnt_hi_u32_b32 v2, -1, v2
  v_lshlrev_b32 v2, 2, v2
  s_mul_i32 s56, s48, 1296
  v_add_u32 v2, s56, v2
  ds_write_b32 v2, v10 offset:0
  ds_write_b32 v2, v11 offset:256
  ds_write_b32 v2, v12 offset:512
  ds_write_b32 v2, v13 offset:768
  ds_write_b32 v2, v14 offset:1024
  s_waitcnt lgkmcnt(0)
  s_branch TE_16
T4_14:
  v_lshlrev_b32 v248, 16, v248
  v_lshlrev_b32 v249, 16, v249
  s_branch TE_16
T3_15:
  v_lshlrev_b32 v15, 16, v15
  v_lshlrev_b32 v3, 2, v2
  ds_write_b32 v3, v15 offset:14464
TE_16:
  s_waitcnt lgkmcnt(0)
  s_barrier
  buffer_load_dwordx4 v[72:75], v30, s[16:19], s68 offen offset:2048 nt
  buffer_load_dwordx4 v[76:79], v30, s[16:19], s68 offen offset:2176 nt
  s_cmp_lg_u32 s49, 1
  s_cbranch_scc1 Q0_17
  v_mbcnt_lo_u32_b32 v24, -1, 0
  v_mbcnt_hi_u32_b32 v24, -1, v24
  v_and_b32 v25, 15, v24
  v_lshrrev_b32 v26, 4, v24
  v_and_b32 v27, 7, v25
  v_lshrrev_b32 v28, 3, v25
  v_mul_u32_u24 v27, 1296, v27
  v_mul_u32_u24 v28, 640, v28
  v_lshl_add_u32 v27, v26, 4, v27
  v_add_u32 v27, v27, v28
  s_lshl_b32 s56, s44, 6
  s_lshl_b32 s57, s50, 3
  s_add_u32 s56, s56, s57
  s_add_u32 s56, s56, s48
  s_lshl_b32 s56, s56, 7
  s_add_u32 s76, s56, 589824
  v_lshlrev_b32 v29, 4, v25
  v_lshl_add_u32 v29, v26, 3, v29
  ds_read_b128 v[4:7], v27 offset:0
  ds_read_b128 v[8:11], v27 offset:64
  ds_read_b128 v[12:15], v27 offset:128
  ds_read_b128 v[16:19], v27 offset:192
  ds_read_b128 v[20:23], v27 offset:256
  s_waitcnt lgkmcnt(4)
  v_mfma_f32_16x16x32_bf16 v[0:3], v[216:219], v[4:7], 0
  ds_read_b128 v[4:7], v27 offset:320
  s_waitcnt lgkmcnt(4)
  v_mfma_f32_16x16x32_bf16 v[0:3], v[220:223], v[8:11], v[0:3]
  ds_read_b128 v[8:11], v27 offset:384
  s_waitcnt lgkmcnt(4)
  v_mfma_f32_16x16x32_bf16 v[0:3], v[224:227], v[12:15], v[0:3]
  ds_read_b128 v[12:15], v27 offset:448
  s_waitcnt lgkmcnt(4)
  v_mfma_f32_16x16x32_bf16 v[0:3], v[228:231], v[16:19], v[0:3]
  ds_read_b128 v[16:19], v27 offset:512
  s_waitcnt lgkmcnt(4)
  v_mfma_f32_16x16x32_bf16 v[0:3], v[232:235], v[20:23], v[0:3]
  ds_read_b128 v[20:23], v27 offset:576
  s_waitcnt lgkmcnt(4)
  v_mfma_f32_16x16x32_bf16 v[0:3], v[236:239], v[4:7], v[0:3]
  s_waitcnt lgkmcnt(3)
  v_mfma_f32_16x16x32_bf16 v[0:3], v[240:243], v[8:11], v[0:3]
  s_waitcnt lgkmcnt(2)
  v_mfma_f32_16x16x32_bf16 v[0:3], v[244:247], v[12:15], v[0:3]
  s_waitcnt lgkmcnt(1)
  v_mfma_f32_16x16x32_bf16 v[0:3], v[248:251], v[16:19], v[0:3]
  s_waitcnt lgkmcnt(0)
  v_mfma_f32_16x16x32_bf16 v[0:3], v[252:255], v[20:23], v[0:3]
  s_nop 7
  s_nop 0
  v_mov_b32_dpp v4, v0 row_ror:8 row_mask:0xf bank_mask:0xf
  v_mov_b32_dpp v5, v1 row_ror:8 row_mask:0xf bank_mask:0xf
  v_mov_b32_dpp v6, v2 row_ror:8 row_mask:0xf bank_mask:0xf
  v_mov_b32_dpp v7, v3 row_ror:8 row_mask:0xf bank_mask:0xf
  s_nop 0
  v_permlane32_swap_b32 v4, v8
  v_permlane32_swap_b32 v5, v9
  v_permlane32_swap_b32 v6, v10
  v_permlane32_swap_b32 v7, v11
  s_nop 0
  v_add_f32 v0, v0, v8
  v_add_f32 v1, v1, v9
  v_add_f32 v2, v2, v10
  v_add_f32 v3, v3, v11
  v_cvt_pk_bf16_f32 v4, v0, v1
  v_cvt_pk_bf16_f32 v5, v2, v3
  v_min_u32 v4, 0xfffffffe, v4
  v_min_u32 v5, 0xfffffffe, v5
Q0_17:
  s_cmp_lg_u32 s49, 1
  s_cbranch_scc1 Q0s_18
  s_mov_b32 exec_lo, 0x00ff00ff
  s_mov_b32 exec_hi, 0
  buffer_store_dwordx2 v[4:5], v29, s[24:27], s76 offen sc1
  s_mov_b64 exec, -1
Q0s_18:
  s_waitcnt vmcnt(11)
  buffer_load_dwordx4 v[80:83], v30, s[16:19], s69 offen offset:0 nt
  s_waitcnt vmcnt(11)
  buffer_load_dwordx4 v[84:87], v30, s[16:19], s69 offen offset:128 nt
  s_waitcnt vmcnt(11)
  buffer_load_dwordx4 v[88:91], v30, s[16:19], s69 offen offset:2048 nt
  s_waitcnt vmcnt(11)
  buffer_load_dwordx4 v[92:95], v30, s[16:19], s69 offen offset:2176 nt
  s_barrier
  s_waitcnt vmcnt(11)
  buffer_load_dwordx4 v[96:99], v30, s[16:19], s70 offen offset:0 nt
  s_waitcnt vmcnt(11)
  buffer_load_dwordx4 v[100:103], v30, s[16:19], s70 offen offset:128 nt
  s_waitcnt vmcnt(11)
  buffer_load_dwordx4 v[104:107], v30, s[16:19], s70 offen offset:2048 nt
  s_waitcnt vmcnt(11)
  buffer_load_dwordx4 v[108:111], v30, s[16:19], s70 offen offset:2176 nt
  s_waitcnt vmcnt(11)
  buffer_load_dwordx4 v[112:115], v30, s[16:19], s71 offen offset:0 nt
  s_waitcnt vmcnt(11)
  buffer_load_dwordx4 v[116:119], v30, s[16:19], s71 offen offset:128 nt
  s_waitcnt vmcnt(11)
  buffer_load_dwordx4 v[120:123], v30, s[16:19], s71 offen offset:2048 nt
  s_waitcnt vmcnt(11)
  buffer_load_dwordx4 v[124:127], v30, s[16:19], s71 offen offset:2176 nt
  s_barrier
  s_waitcnt vmcnt(11)
  buffer_load_dwordx4 v[128:131], v30, s[16:19], s72 offen offset:0 nt
  s_waitcnt vmcnt(11)
  buffer_load_dwordx4 v[132:135], v30, s[16:19], s72 offen offset:128 nt
  s_waitcnt vmcnt(11)
  buffer_load_dwordx4 v[136:139], v30, s[16:19], s72 offen offset:2048 nt
  s_waitcnt vmcnt(11)
  buffer_load_dwordx4 v[140:143], v30, s[16:19], s72 offen offset:2176 nt
  s_waitcnt vmcnt(11)
  buffer_load_dwordx4 v[144:147], v30, s[16:19], s73 offen offset:0 nt
  s_waitcnt vmcnt(11)
  buffer_load_dwordx4 v[148:151], v30, s[16:19], s73 offen offset:128 nt
  s_waitcnt vmcnt(11)
  buffer_load_dwordx4 v[152:155], v30, s[16:19], s73 offen offset:2048 nt
  s_waitcnt vmcnt(11)
  buffer_load_dwordx4 v[156:159], v30, s[16:19], s73 offen offset:2176 nt
  s_barrier
  s_waitcnt vmcnt(11)
  s_add_u32 m0, s74, 0
  s_nop 0
  buffer_load_dwordx4 v31, s[20:23], s66 offen offset:0 nt lds
  s_waitcnt vmcnt(11)
  s_add_u32 m0, s74, 1024
  s_nop 0
  buffer_load_dwordx4 v31, s[20:23], s67 offen offset:0 nt lds
  s_waitcnt vmcnt(11)
  s_add_u32 m0, s74, 1792
  s_nop 0
  buffer_load_dwordx4 v31, s[20:23], s66 offen offset:256 nt lds
  s_waitcnt vmcnt(11)
  s_add_u32 m0, s74, 2816
  s_nop 0
  buffer_load_dwordx4 v31, s[20:23], s67 offen offset:256 nt lds
  s_waitcnt vmcnt(11)
  s_add_u32 m0, s74, 3584
  s_nop 0
  buffer_load_dwordx4 v31, s[20:23], s66 offen offset:512 nt lds
  s_waitcnt vmcnt(11)
  s_add_u32 m0, s74, 4608
  s_nop 0
  buffer_load_dwordx4 v31, s[20:23], s67 offen offset:512 nt lds
  s_waitcnt vmcnt(11)
  s_add_u32 m0, s74, 5376
  s_nop 0
  buffer_load_dwordx4 v31, s[20:23], s66 offen offset:768 nt lds
  s_waitcnt vmcnt(11)
  s_add_u32 m0, s74, 6400
  s_nop 0
  buffer_load_dwordx4 v31, s[20:23], s67 offen offset:768 nt lds
  s_barrier
  s_waitcnt vmcnt(11)
  s_add_u32 m0, s74, 7168
  s_nop 0
  buffer_load_dwordx4 v31, s[20:23], s66 offen offset:1024 nt lds
  s_waitcnt vmcnt(11)
  s_add_u32 m0, s74, 8192
  s_nop 0
  buffer_load_dwordx4 v31, s[20:23], s67 offen offset:1024 nt lds
  s_load_dwordx8 s[8:15], s[28:29], 0
  s_waitcnt lgkmcnt(0)
  s_and_b32 s56, s8, s9
  s_and_b32 s56, s56, s10
  s_and_b32 s56, s56, s11
  s_and_b32 s56, s56, s12
  s_and_b32 s56, s56, s13
  s_and_b32 s56, s56, s14
  s_and_b32 s56, s56, s15
  s_bitcmp1_b32 s56, 30
  s_cbranch_scc1 TBD_20
  v_mbcnt_lo_u32_b32 v16, -1, 0
  v_mbcnt_hi_u32_b32 v16, -1, v16
  v_and_b32 v16, 7, v16
  v_lshlrev_b32 v16, 2, v16
TB_19:
  s_sleep 32
  buffer_load_dword v17, v16, s[28:31], 0 offen sc1
  s_waitcnt vmcnt(0)
  v_cmp_gt_u32 vcc, 0x40000000, v17
  s_cmp_eq_u64 vcc, 0
  s_cbranch_scc1 TBE_21
  s_add_u32 s53, s53, 1
  s_cmp_lt_u32 s53, 400000
  s_cbranch_scc1 TB_19
TBE_21:
  s_load_dwordx8 s[8:15], s[28:29], 0 glc
  s_waitcnt lgkmcnt(0)
TBD_20:
  v_mbcnt_lo_u32_b32 v26, -1, 0
  v_mbcnt_hi_u32_b32 v26, -1, v26
  v_lshrrev_b32 v29, 5, v26
  v_lshlrev_b32 v29, 3, v29
  v_bfe_u32 v27, v26, 1, 1
  v_lshl_add_u32 v29, v27, 2, v29
  v_bfe_u32 v27, v26, 4, 1
  v_lshl_add_u32 v29, v27, 1, v29
  v_and_b32 v27, 1, v26
  v_lshlrev_b32 v27, 2, v27
  v_lshl_add_u32 v29, v29, 7, v27
  s_lshl_b32 s56, s46, 11
  s_lshl_b32 s57, s47, 4
  s_add_u32 s56, s56, s57
  s_add_u32 s56, s56, s52
  s_add_u32 s59, s56, 589824
  buffer_load_dword v0, v29, s[24:27], s59 offen offset:0 sc1
  buffer_load_dword v1, v29, s[24:27], s59 offen offset:8 sc1
  buffer_load_dword v2, v29, s[24:27], s59 offen offset:128 sc1
  buffer_load_dword v3, v29, s[24:27], s59 offen offset:136 sc1
  s_waitcnt vmcnt(15)
  s_add_u32 m0, s74, 8960
  s_nop 0
  buffer_load_dwordx4 v31, s[20:23], s66 offen offset:1280 nt lds
  s_waitcnt vmcnt(15)
  s_add_u32 m0, s74, 9984
  s_nop 0
  buffer_load_dwordx4 v31, s[20:23], s67 offen offset:1280 nt lds
  s_waitcnt vmcnt(15)
  s_add_u32 m0, s74, 10752
  s_nop 0
  buffer_load_dwordx4 v31, s[20:23], s66 offen offset:1536 nt lds
  s_waitcnt vmcnt(15)
  s_add_u32 m0, s74, 11776
  s_nop 0
  buffer_load_dwordx4 v31, s[20:23], s67 offen offset:1536 nt lds
  s_waitcnt vmcnt(15)
  s_add_u32 m0, s74, 12544
  s_nop 0
  buffer_load_dwordx4 v31, s[20:23], s66 offen offset:1792 nt lds
  s_waitcnt vmcnt(15)
  s_add_u32 m0, s74, 13568
  s_nop 0
  buffer_load_dwordx4 v31, s[20:23], s67 offen offset:1792 nt lds
  s_barrier
  s_waitcnt vmcnt(15)
  s_add_u32 m0, s74, 16384
  s_nop 0
  buffer_load_dwordx4 v31, s[20:23], s68 offen offset:0 nt lds
  s_waitcnt vmcnt(15)
  s_add_u32 m0, s74, 17408
  s_nop 0
  buffer_load_dwordx4 v31, s[20:23], s69 offen offset:0 nt lds
  s_waitcnt vmcnt(8)
  s_branch QC_24
QP_22:
  buffer_load_dword v0, v29, s[24:27], s59 offen offset:0 sc1
  buffer_load_dword v1, v29, s[24:27], s59 offen offset:8 sc1
  buffer_load_dword v2, v29, s[24:27], s59 offen offset:128 sc1
  buffer_load_dword v3, v29, s[24:27], s59 offen offset:136 sc1
  s_waitcnt vmcnt(0)
QC_24:
  v_max3_u32 v28, v0, v1, v2
  v_max_u32 v28, v28, v3
  v_cmp_eq_u32 vcc, -1, v28
  s_cmp_eq_u64 vcc, 0
  s_cbranch_scc1 QPD_23
  s_add_u32 s53, s53, 1
  s_cmp_lt_u32 s53, 400000
  s_cbranch_scc1 QP_22
QPD_23:
  s_load_dword s7, s[28:29], 128
  s_mov_b32 s51, 0
  s_bfe_u32 s56, s8, 524305
  s_bfe_u32 s57, s8, 720902
  s_mul_i32 s56, s56, s56
  s_lshl_b32 s57, s57, 5
  s_xor_b32 s56, s56, s57
  s_or_b32 s51, s51, s56
  s_bfe_u32 s56, s9, 524305
  s_bfe_u32 s57, s9, 720902
  s_mul_i32 s56, s56, s56
  s_lshl_b32 s57, s57, 5
  s_xor_b32 s56, s56, s57
  s_or_b32 s51, s51, s56
  s_bfe_u32 s56, s10, 524305
  s_bfe_u32 s57, s10, 720902
  s_mul_i32 s56, s56, s56
  s_lshl_b32 s57, s57, 5
  s_xor_b32 s56, s56, s57
  s_or_b32 s51, s51, s56
  s_bfe_u32 s56, s11, 524305
  s_bfe_u32 s57, s11, 720902
  s_mul_i32 s56, s56, s56
  s_lshl_b32 s57, s57, 5
  s_xor_b32 s56, s56, s57
  s_or_b32 s51, s51, s56
  s_bfe_u32 s56, s12, 524305
  s_bfe_u32 s57, s12, 720902
  s_mul_i32 s56, s56, s56
  s_lshl_b32 s57, s57, 5
  s_xor_b32 s56, s56, s57
  s_or_b32 s51, s51, s56
  s_bfe_u32 s56, s13, 524305
  s_bfe_u32 s57, s13, 720902
  s_mul_i32 s56, s56, s56
  s_lshl_b32 s57, s57, 5
  s_xor_b32 s56, s56, s57
  s_or_b32 s51, s51, s56
  s_bfe_u32 s56, s14, 524305
  s_bfe_u32 s57, s14, 720902
  s_mul_i32 s56, s56, s56
  s_lshl_b32 s57, s57, 5
  s_xor_b32 s56, s56, s57
  s_or_b32 s51, s51, s56
  s_bfe_u32 s56, s15, 524305
  s_bfe_u32 s57, s15, 720902
  s_mul_i32 s56, s56, s56
  s_lshl_b32 s57, s57, 5
  s_xor_b32 s56, s56, s57
  s_or_b32 s51, s51, s56
  s_cmp_eq_u32 s51, 0
  s_cselect_b32 s51, 1, 0
  s_waitcnt lgkmcnt(0)
  s_and_b32 s76, s7, 0xffff
  s_lshl_b32 s76, s76, 1
  s_lshr_b32 s7, s7, 16
  s_cmp_ge_u32 s76, s7
  s_cselect_b32 s76, 0, 1
  s_getreg_b32 s56, hwreg(HW_REG_XCC_ID)
  s_bfe_u32 s56, s56, 65538
  s_xor_b32 s76, s76, s56
  s_lshl_b32 s54, s76, 13
L_att:
  v_mbcnt_lo_u32_b32 v24, -1, 0
  v_mbcnt_hi_u32_b32 v24, -1, v24
  v_mov_b32 v16, 0
  v_mov_b32 v17, 0
  v_mov_b32 v18, 0
  v_mov_b32 v19, 0
  v_mov_b32 v20, 0
  v_mov_b32 v21, 0
  v_mov_b32 v22, 0
  v_mov_b32 v23, 0
  v_and_b32 v24, 1, v24
  v_mul_u32_u24 v24, 0xaaaa, v24
  v_add_u32 v24, 0x4444, v24
  s_mov_b32 s60, 0x000f000f
  s_mov_b32 s61, 0x000f000f
  s_waitcnt lgkmcnt(0)
  s_lshl_b64 s[62:63], s[60:61], 12
  v_cndmask_b32 v12, 0, v0, s[62:63]
  v_cndmask_b32 v13, 0, v1, s[62:63]
  v_cndmask_b32 v14, 0, v2, s[62:63]
  v_cndmask_b32 v15, 0, v3, s[62:63]
  s_lshl_b64 s[62:63], s[60:61], 8
  v_cndmask_b32 v8, 0, v0, s[62:63]
  v_cndmask_b32 v9, 0, v1, s[62:63]
  v_cndmask_b32 v10, 0, v2, s[62:63]
  v_cndmask_b32 v11, 0, v3, s[62:63]
  s_lshl_b64 s[62:63], s[60:61], 4
  v_cndmask_b32 v4, 0, v0, s[62:63]
  v_cndmask_b32 v5, 0, v1, s[62:63]
  v_cndmask_b32 v6, 0, v2, s[62:63]
  v_cndmask_b32 v7, 0, v3, s[62:63]
  s_lshl_b64 s[62:63], s[60:61], 0
  v_cndmask_b32 v0, 0, v0, s[62:63]
  v_cndmask_b32 v1, 0, v1, s[62:63]
  v_cndmask_b32 v2, 0, v2, s[62:63]
  v_cndmask_b32 v3, 0, v3, s[62:63]
  s_mov_b32 s60, 0xff00ff00
  s_mov_b32 s61, 0xff00ff00
  v_smfmac_f32_16x16x64_bf16 v[16:19], v[12:15], v[56:63], v24
  v_smfmac_f32_16x16x64_bf16 v[20:23], v[12:15], v[88:95], v24
  v_smfmac_f32_16x16x64_bf16 v[16:19], v[8:11], v[48:55], v24
  v_smfmac_f32_16x16x64_bf16 v[20:23], v[8:11], v[80:87], v24
  v_smfmac_f32_16x16x64_bf16 v[16:19], v[4:7], v[40:47], v24
  v_smfmac_f32_16x16x64_bf16 v[20:23], v[4:7], v[72:79], v24
  v_smfmac_f32_16x16x64_bf16 v[16:19], v[0:3], v[32:39], v24
  v_smfmac_f32_16x16x64_bf16 v[20:23], v[0:3], v[64:71], v24
  s_nop 7
  v_add_f32 v16, v16, v17
  v_add_f32 v18, v18, v19
  v_add_f32 v20, v20, v21
  v_add_f32 v22, v22, v23
  v_cndmask_b32 v25, v16, v18, s[60:61]
  v_cndmask_b32 v26, v20, v22, s[60:61]
  v_mov_b32 v16, 0
  v_mov_b32 v17, 0
  v_mov_b32 v18, 0
  v_mov_b32 v19, 0
  v_mov_b32 v20, 0
  v_mov_b32 v21, 0
  v_mov_b32 v22, 0
  v_mov_b32 v23, 0
  s_nop 0
  v_smfmac_f32_16x16x64_bf16 v[16:19], v[12:15], v[120:127], v24
  v_smfmac_f32_16x16x64_bf16 v[20:23], v[12:15], v[152:159], v24
  v_smfmac_f32_16x16x64_bf16 v[16:19], v[8:11], v[112:119], v24
  v_smfmac_f32_16x16x64_bf16 v[20:23], v[8:11], v[144:151], v24
  v_smfmac_f32_16x16x64_bf16 v[16:19], v[4:7], v[104:111], v24
  v_smfmac_f32_16x16x64_bf16 v[20:23], v[4:7], v[136:143], v24
  v_smfmac_f32_16x16x64_bf16 v[16:19], v[0:3], v[96:103], v24
  v_smfmac_f32_16x16x64_bf16 v[20:23], v[0:3], v[128:135], v24
  s_nop 7
  v_add_f32 v16, v16, v17
  v_add_f32 v18, v18, v19
  v_add_f32 v20, v20, v21
  v_add_f32 v22, v22, v23
  v_cndmask_b32 v16, v16, v18, s[60:61]
  v_cndmask_b32 v20, v20, v22, s[60:61]
  s_nop 0
  v_add_f32_dpp v25, v25, v25 row_ror:8 row_mask:0xf bank_mask:0xf
  v_add_f32_dpp v26, v26, v26 row_ror:8 row_mask:0xf bank_mask:0xf
  v_add_f32_dpp v16, v16, v16 row_ror:8 row_mask:0xf bank_mask:0xf
  v_add_f32_dpp v20, v20, v20 row_ror:8 row_mask:0xf bank_mask:0xf
  v_cndmask_b32 v28, v25, v26, s[60:61]
  v_cndmask_b32 v29, v16, v20, s[60:61]
  v_cvt_pk_bf16_f32 v4, v28, v29
  v_lshlrev_b32 v2, 16, v4
  v_and_b32 v3, 0xffff0000, v4
  v_mul_f32 v2, 0x3db504f3, v2
  v_mul_f32 v3, 0x3db504f3, v3
  v_cvt_pk_bf16_f32 v4, v2, v3
  v_lshlrev_b32 v2, 16, v4
  v_and_b32 v3, 0xffff0000, v4
  v_mov_b32 v4, 0xff7fffff
  v_max3_f32 v5, v2, v3, v4
  s_nop 1
  v_max_f32_dpp v5, v5, v5 row_shr:1 row_mask:0xf bank_mask:0xf
  s_nop 1
  v_max_f32_dpp v5, v5, v5 row_shr:2 row_mask:0xf bank_mask:0xf
  s_nop 1
  v_max_f32_dpp v5, v5, v5 row_shr:4 row_mask:0xf bank_mask:0xf
  s_nop 1
  v_max_f32_dpp v5, v5, v5 row_shr:8 row_mask:0xf bank_mask:0xf
  s_nop 1
  v_max_f32_dpp v5, v5, v5 row_bcast:15 row_mask:0xa bank_mask:0xf
  s_nop 1
  v_max_f32_dpp v5, v5, v5 row_bcast:31 row_mask:0xc bank_mask:0xf
  s_nop 1
  v_readlane_b32 s65, v5, 63
  s_nop 1
  v_subrev_f32 v2, s65, v2
  v_subrev_f32 v3, s65, v3
  v_mul_f32 v2, 0x3fb8aa3b, v2
  v_mul_f32 v3, 0x3fb8aa3b, v3
  v_exp_f32 v2, v2
  v_exp_f32 v3, v3
  s_nop 0
  v_add_f32 v5, v2, v3
  s_nop 1
  v_add_f32_dpp v5, v5, v5 row_shr:1 row_mask:0xf bank_mask:0xf
  s_nop 1
  v_add_f32_dpp v5, v5, v5 row_shr:2 row_mask:0xf bank_mask:0xf
  s_nop 1
  v_add_f32_dpp v5, v5, v5 row_shr:4 row_mask:0xf bank_mask:0xf
  s_nop 1
  v_add_f32_dpp v5, v5, v5 row_shr:8 row_mask:0xf bank_mask:0xf
  s_nop 1
  v_add_f32_dpp v5, v5, v5 row_bcast:15 row_mask:0xa bank_mask:0xf
  s_nop 1
  v_add_f32_dpp v5, v5, v5 row_bcast:31 row_mask:0xc bank_mask:0xf
  s_nop 1
  v_readlane_b32 s57, v5, 63
  s_lshl_b32 s58, s48, 3
  v_mov_b32 v6, s65
  v_mov_b32 v7, s57
  v_mov_b32 v8, s58
  s_mov_b64 exec, 1
  ds_write_b64 v8, v[6:7] offset:14720
  s_mov_b64 exec, -1
  s_cmp_lg_u32 s52, 0
  s_cbranch_scc1 VR_25
  v_mbcnt_lo_u32_b32 v29, -1, 0
  v_mbcnt_hi_u32_b32 v29, -1, v29
  s_lshl_b32 s56, s48, 15
  v_and_b32 v30, 7, v29
  v_lshlrev_b32 v30, 8, v30
  v_bfe_u32 v31, v29, 3, 1
  v_lshl_add_u32 v30, v31, 6, v30
  v_lshrrev_b32 v31, 4, v29
  v_lshl_add_u32 v30, v31, 4, v30
  v_add_u32 v30, s56, v30
  v_and_b32 v31, 15, v29
  v_lshlrev_b32 v31, 4, v31
  v_add_u32 v31, s56, v31
  v_bfe_u32 v28, v29, 4, 1
  v_lshl_add_u32 v31, v28, 14, v31
  v_lshrrev_b32 v28, 5, v29
  v_lshl_add_u32 v31, v28, 11, v31
  s_waitcnt vmcnt(12)
  buffer_load_dwordx4 v[160:163], v31, s[20:23], s68 offen offset:256 nt
  s_waitcnt vmcnt(13)
  buffer_load_dwordx4 v[164:167], v31, s[20:23], s69 offen offset:256 nt
  s_waitcnt vmcnt(14)
  buffer_load_dwordx4 v[168:171], v31, s[20:23], s68 offen offset:512 nt
  s_waitcnt vmcnt(15)
  buffer_load_dwordx4 v[172:175], v31, s[20:23], s69 offen offset:512 nt
  s_waitcnt vmcnt(16)
  buffer_load_dwordx4 v[176:179], v31, s[20:23], s68 offen offset:768 nt
  s_waitcnt vmcnt(17)
  buffer_load_dwordx4 v[180:183], v31, s[20:23], s69 offen offset:768 nt
  s_waitcnt vmcnt(18)
  buffer_load_dwordx4 v[184:187], v31, s[20:23], s68 offen offset:1024 nt
  s_waitcnt vmcnt(19)
  buffer_load_dwordx4 v[188:191], v31, s[20:23], s69 offen offset:1024 nt
  s_waitcnt vmcnt(19)
  buffer_load_dwordx4 v[192:195], v31, s[20:23], s68 offen offset:1280 nt
  s_waitcnt vmcnt(19)
  buffer_load_dwordx4 v[196:199], v31, s[20:23], s69 offen offset:1280 nt
  s_waitcnt vmcnt(19)
  buffer_load_dwordx4 v[200:203], v31, s[20:23], s68 offen offset:1536 nt
  s_waitcnt vmcnt(19)
  buffer_load_dwordx4 v[204:207], v31, s[20:23], s69 offen offset:1536 nt
  s_waitcnt vmcnt(19)
  buffer_load_dwordx4 v[208:211], v31, s[20:23], s68 offen offset:1792 nt
  s_waitcnt vmcnt(19)
  buffer_load_dwordx4 v[212:215], v31, s[20:23], s69 offen offset:1792 nt
VR_25:
  v_mbcnt_lo_u32_b32 v8, -1, 0
  v_mbcnt_hi_u32_b32 v8, -1, v8
  v_and_b32 v9, 7, v8
  v_lshlrev_b32 v9, 3, v9
  v_and_b32 v11, 3, v8
  v_mul_u32_u24 v11, 0x5555, v11
  v_bfe_u32 v8, v8, 2, 2
  v_mov_b32 v4, 0xffff
  v_cmp_eq_u32 vcc, 0, v8
  s_nop 1
  v_cndmask_b32 v14, 0, v4, vcc
  v_cmp_eq_u32 vcc, 1, v8
  s_nop 1
  v_cndmask_b32 v15, 0, v4, vcc
  s_waitcnt lgkmcnt(0)
  v_mbcnt_lo_u32_b32 v10, -1, 0
  v_mbcnt_hi_u32_b32 v10, -1, v10
  v_lshlrev_b32 v10, 4, v10
  v_add_u32 v10, s74, v10
  s_lshl_b32 s56, s44, 13
  s_lshl_b32 s57, s47, 10
  s_add_u32 s56, s56, s57
  s_and_b32 s57, s46, 3
  s_lshl_b32 s57, s57, 8
  s_add_u32 s56, s56, s57
  s_add_u32 s56, s56, s52
  s_add_u32 s76, s56, 327680
  s_waitcnt vmcnt(14)
  ds_read_b128 v[16:19], v10 offset:0
  ds_read_b128 v[20:23], v10 offset:1024
  ds_read_b128 v[24:27], v10 offset:2048
  ds_read_b128 v[28:31], v10 offset:3072
  s_barrier
  ds_read_b64 v[6:7], v9 offset:14720
  s_waitcnt lgkmcnt(0)
  v_mov_b32 v8, v6
  s_nop 1
  v_max_f32_dpp v8, v8, v8 row_ror:1 row_mask:0xf bank_mask:0xf
  s_nop 1
  v_max_f32_dpp v8, v8, v8 row_ror:2 row_mask:0xf bank_mask:0xf
  s_nop 1
  v_max_f32_dpp v8, v8, v8 row_ror:4 row_mask:0xf bank_mask:0xf
  v_sub_f32 v6, v6, v8
  v_sub_f32 v9, s65, v8
  v_mul_f32 v6, 0x3fb8aa3b, v6
  v_mul_f32 v9, 0x3fb8aa3b, v9
  v_exp_f32 v6, v6
  v_exp_f32 v9, v9
  s_nop 0
  v_mul_f32 v7, v7, v6
  v_mul_f32 v2, v2, v9
  v_mul_f32 v3, v3, v9
  v_add_f32_dpp v7, v7, v7 row_ror:1 row_mask:0xf bank_mask:0xf
  s_nop 1
  v_add_f32_dpp v7, v7, v7 row_ror:2 row_mask:0xf bank_mask:0xf
  s_nop 1
  v_add_f32_dpp v7, v7, v7 row_ror:4 row_mask:0xf bank_mask:0xf
  v_rcp_f32 v7, v7
  s_nop 0
  v_mul_f32 v2, v2, v7
  v_mul_f32 v3, v3, v7
  v_cvt_pk_bf16_f32 v12, v2, v2
  v_cvt_pk_bf16_f32 v13, v3, v3
  s_nop 1
  v_mov_b32 v0, 0
  v_mov_b32 v1, 0
  v_mov_b32 v2, 0
  v_mov_b32 v3, 0
  v_and_b32_dpp v4, v12, v14 row_newbcast:0 row_mask:0xf bank_mask:0xf
  v_and_b32_dpp v5, v12, v15 row_newbcast:0 row_mask:0xf bank_mask:0xf
  v_and_b32_dpp v6, v13, v14 row_newbcast:0 row_mask:0xf bank_mask:0xf
  v_and_b32_dpp v7, v13, v15 row_newbcast:0 row_mask:0xf bank_mask:0xf
  s_waitcnt lgkmcnt(2)
  s_nop 0
  v_smfmac_f32_16x16x64_bf16 v[0:3], v[4:7], v[16:23], v11
  ds_read_b128 v[16:19], v10 offset:4096
  ds_read_b128 v[20:23], v10 offset:5120
  v_and_b32_dpp v4, v12, v14 row_newbcast:9 row_mask:0xf bank_mask:0xf
  v_and_b32_dpp v5, v12, v15 row_newbcast:9 row_mask:0xf bank_mask:0xf
  v_and_b32_dpp v6, v13, v14 row_newbcast:9 row_mask:0xf bank_mask:0xf
  v_and_b32_dpp v7, v13, v15 row_newbcast:9 row_mask:0xf bank_mask:0xf
  s_waitcnt vmcnt(12)
  s_nop 0
  v_smfmac_f32_16x16x64_bf16 v[0:3], v[4:7], v[160:167], v11
  v_and_b32_dpp v4, v12, v14 row_newbcast:1 row_mask:0xf bank_mask:0xf
  v_and_b32_dpp v5, v12, v15 row_newbcast:1 row_mask:0xf bank_mask:0xf
  v_and_b32_dpp v6, v13, v14 row_newbcast:1 row_mask:0xf bank_mask:0xf
  v_and_b32_dpp v7, v13, v15 row_newbcast:1 row_mask:0xf bank_mask:0xf
  s_waitcnt lgkmcnt(2)
  s_nop 0
  v_smfmac_f32_16x16x64_bf16 v[0:3], v[4:7], v[24:31], v11
  ds_read_b128 v[24:27], v10 offset:6144
  ds_read_b128 v[28:31], v10 offset:7168
  v_and_b32_dpp v4, v12, v14 row_newbcast:10 row_mask:0xf bank_mask:0xf
  v_and_b32_dpp v5, v12, v15 row_newbcast:10 row_mask:0xf bank_mask:0xf
  v_and_b32_dpp v6, v13, v14 row_newbcast:10 row_mask:0xf bank_mask:0xf
  v_and_b32_dpp v7, v13, v15 row_newbcast:10 row_mask:0xf bank_mask:0xf
  s_waitcnt vmcnt(10)
  s_nop 0
  v_smfmac_f32_16x16x64_bf16 v[0:3], v[4:7], v[168:175], v11
  v_and_b32_dpp v4, v12, v14 row_newbcast:2 row_mask:0xf bank_mask:0xf
  v_and_b32_dpp v5, v12, v15 row_newbcast:2 row_mask:0xf bank_mask:0xf
  v_and_b32_dpp v6, v13, v14 row_newbcast:2 row_mask:0xf bank_mask:0xf
  v_and_b32_dpp v7, v13, v15 row_newbcast:2 row_mask:0xf bank_mask:0xf
  s_waitcnt lgkmcnt(2)
  s_nop 0
  v_smfmac_f32_16x16x64_bf16 v[0:3], v[4:7], v[16:23], v11
  ds_read_b128 v[16:19], v10 offset:8192
  ds_read_b128 v[20:23], v10 offset:9216
  v_and_b32_dpp v4, v12, v14 row_newbcast:3 row_mask:0xf bank_mask:0xf
  v_and_b32_dpp v5, v12, v15 row_newbcast:3 row_mask:0xf bank_mask:0xf
  v_and_b32_dpp v6, v13, v14 row_newbcast:3 row_mask:0xf bank_mask:0xf
  v_and_b32_dpp v7, v13, v15 row_newbcast:3 row_mask:0xf bank_mask:0xf
  s_waitcnt lgkmcnt(2)
  s_nop 0
  v_smfmac_f32_16x16x64_bf16 v[0:3], v[4:7], v[24:31], v11
  ds_read_b128 v[24:27], v10 offset:10240
  ds_read_b128 v[28:31], v10 offset:11264
  v_and_b32_dpp v4, v12, v14 row_newbcast:11 row_mask:0xf bank_mask:0xf
  v_and_b32_dpp v5, v12, v15 row_newbcast:11 row_mask:0xf bank_mask:0xf
  v_and_b32_dpp v6, v13, v14 row_newbcast:11 row_mask:0xf bank_mask:0xf
  v_and_b32_dpp v7, v13, v15 row_newbcast:11 row_mask:0xf bank_mask:0xf
  s_waitcnt vmcnt(8)
  s_nop 0
  v_smfmac_f32_16x16x64_bf16 v[0:3], v[4:7], v[176:183], v11
  v_and_b32_dpp v4, v12, v14 row_newbcast:4 row_mask:0xf bank_mask:0xf
  v_and_b32_dpp v5, v12, v15 row_newbcast:4 row_mask:0xf bank_mask:0xf
  v_and_b32_dpp v6, v13, v14 row_newbcast:4 row_mask:0xf bank_mask:0xf
  v_and_b32_dpp v7, v13, v15 row_newbcast:4 row_mask:0xf bank_mask:0xf
  s_waitcnt lgkmcnt(2)
  s_nop 0
  v_smfmac_f32_16x16x64_bf16 v[0:3], v[4:7], v[16:23], v11
  ds_read_b128 v[16:19], v10 offset:12288
  ds_read_b128 v[20:23], v10 offset:13312
  v_and_b32_dpp v4, v12, v14 row_newbcast:5 row_mask:0xf bank_mask:0xf
  v_and_b32_dpp v5, v12, v15 row_newbcast:5 row_mask:0xf bank_mask:0xf
  v_and_b32_dpp v6, v13, v14 row_newbcast:5 row_mask:0xf bank_mask:0xf
  v_and_b32_dpp v7, v13, v15 row_newbcast:5 row_mask:0xf bank_mask:0xf
  s_waitcnt lgkmcnt(2)
  s_nop 0
  v_smfmac_f32_16x16x64_bf16 v[0:3], v[4:7], v[24:31], v11
  ds_read_b128 v[24:27], v10 offset:14336
  ds_read_b128 v[28:31], v10 offset:15360
  v_and_b32_dpp v4, v12, v14 row_newbcast:12 row_mask:0xf bank_mask:0xf
  v_and_b32_dpp v5, v12, v15 row_newbcast:12 row_mask:0xf bank_mask:0xf
  v_and_b32_dpp v6, v13, v14 row_newbcast:12 row_mask:0xf bank_mask:0xf
  v_and_b32_dpp v7, v13, v15 row_newbcast:12 row_mask:0xf bank_mask:0xf
  s_waitcnt vmcnt(6)
  s_nop 0
  v_smfmac_f32_16x16x64_bf16 v[0:3], v[4:7], v[184:191], v11
  v_and_b32_dpp v4, v12, v14 row_newbcast:6 row_mask:0xf bank_mask:0xf
  v_and_b32_dpp v5, v12, v15 row_newbcast:6 row_mask:0xf bank_mask:0xf
  v_and_b32_dpp v6, v13, v14 row_newbcast:6 row_mask:0xf bank_mask:0xf
  v_and_b32_dpp v7, v13, v15 row_newbcast:6 row_mask:0xf bank_mask:0xf
  s_waitcnt lgkmcnt(2)
  s_nop 0
  v_smfmac_f32_16x16x64_bf16 v[0:3], v[4:7], v[16:23], v11
  ds_read_b128 v[16:19], v10 offset:16384
  ds_read_b128 v[20:23], v10 offset:17408
  v_and_b32_dpp v4, v12, v14 row_newbcast:7 row_mask:0xf bank_mask:0xf
  v_and_b32_dpp v5, v12, v15 row_newbcast:7 row_mask:0xf bank_mask:0xf
  v_and_b32_dpp v6, v13, v14 row_newbcast:7 row_mask:0xf bank_mask:0xf
  v_and_b32_dpp v7, v13, v15 row_newbcast:7 row_mask:0xf bank_mask:0xf
  s_waitcnt lgkmcnt(2)
  s_nop 0
  v_smfmac_f32_16x16x64_bf16 v[0:3], v[4:7], v[24:31], v11
  v_and_b32_dpp v4, v12, v14 row_newbcast:13 row_mask:0xf bank_mask:0xf
  v_and_b32_dpp v5, v12, v15 row_newbcast:13 row_mask:0xf bank_mask:0xf
  v_and_b32_dpp v6, v13, v14 row_newbcast:13 row_mask:0xf bank_mask:0xf
  v_and_b32_dpp v7, v13, v15 row_newbcast:13 row_mask:0xf bank_mask:0xf
  s_waitcnt vmcnt(4)
  s_nop 0
  v_smfmac_f32_16x16x64_bf16 v[0:3], v[4:7], v[192:199], v11
  v_and_b32_dpp v4, v12, v14 row_newbcast:8 row_mask:0xf bank_mask:0xf
  v_and_b32_dpp v5, v12, v15 row_newbcast:8 row_mask:0xf bank_mask:0xf
  v_and_b32_dpp v6, v13, v14 row_newbcast:8 row_mask:0xf bank_mask:0xf
  v_and_b32_dpp v7, v13, v15 row_newbcast:8 row_mask:0xf bank_mask:0xf
  s_waitcnt lgkmcnt(0)
  s_nop 0
  v_smfmac_f32_16x16x64_bf16 v[0:3], v[4:7], v[16:23], v11
  v_and_b32_dpp v4, v12, v14 row_newbcast:14 row_mask:0xf bank_mask:0xf
  v_and_b32_dpp v5, v12, v15 row_newbcast:14 row_mask:0xf bank_mask:0xf
  v_and_b32_dpp v6, v13, v14 row_newbcast:14 row_mask:0xf bank_mask:0xf
  v_and_b32_dpp v7, v13, v15 row_newbcast:14 row_mask:0xf bank_mask:0xf
  s_waitcnt vmcnt(2)
  s_nop 0
  v_smfmac_f32_16x16x64_bf16 v[0:3], v[4:7], v[200:207], v11
  v_and_b32_dpp v4, v12, v14 row_newbcast:15 row_mask:0xf bank_mask:0xf
  v_and_b32_dpp v5, v12, v15 row_newbcast:15 row_mask:0xf bank_mask:0xf
  v_and_b32_dpp v6, v13, v14 row_newbcast:15 row_mask:0xf bank_mask:0xf
  v_and_b32_dpp v7, v13, v15 row_newbcast:15 row_mask:0xf bank_mask:0xf
  s_waitcnt vmcnt(0)
  s_nop 0
  v_smfmac_f32_16x16x64_bf16 v[0:3], v[4:7], v[208:215], v11
  v_mbcnt_lo_u32_b32 v31, -1, 0
  v_mbcnt_hi_u32_b32 v31, -1, v31
  v_and_b32 v29, 15, v31
  v_lshrrev_b32 v30, 4, v31
  v_lshlrev_b32 v29, 5, v29
  v_lshl_add_u32 v29, v30, 4, v29
  s_lshl_b32 s56, s48, 9
  v_add_u32 v29, s56, v29
  v_lshlrev_b32 v30, 3, v31
  v_lshlrev_b32 v31, 2, v31
  s_cmp_lg_u32 s49, 4
  s_cbranch_scc1 PCL_26
  s_cmp_lg_u32 s52, 0
  s_cbranch_scc1 PCL_26
  v_mov_b32 v24, -1
  v_mov_b32 v25, -1
  v_mov_b32 v26, -1
  v_mov_b32 v27, -1
  v_lshlrev_b32 v23, 2, v31
  s_mul_i32 s3, s44, 10
  s_add_u32 s3, s3, s50
  s_lshl_b32 s3, s3, 3
  s_add_u32 s3, s3, s48
  s_lshl_b32 s3, s3, 11
  s_add_u32 s3, s3, 655360
  buffer_store_dwordx4 v[24:27], v23, s[24:27], s3 offen sc1
  buffer_store_dwordx4 v[24:27], v23, s[24:27], s3 offen offset:1024 sc1
  s_waitcnt vmcnt(0)
PCL_26:
  s_mov_b32 exec_hi, 0
  ds_write_b128 v29, v[0:3] offset:10368
  s_mov_b64 exec, -1
  s_waitcnt lgkmcnt(0)
  s_barrier
  s_cmp_lg_u32 s48, 0
  s_cbranch_scc1 OF_27
  ds_read_b64 v[0:1], v30 offset:10368
  ds_read_b64 v[2:3], v30 offset:10880
  ds_read_b64 v[4:5], v30 offset:11392
  ds_read_b64 v[6:7], v30 offset:11904
  ds_read_b64 v[8:9], v30 offset:12416
  ds_read_b64 v[10:11], v30 offset:12928
  ds_read_b64 v[12:13], v30 offset:13440
  ds_read_b64 v[14:15], v30 offset:13952
  s_waitcnt lgkmcnt(6)
  v_pk_add_f32 v[0:1], v[0:1], v[2:3]
  s_waitcnt lgkmcnt(5)
  v_pk_add_f32 v[0:1], v[0:1], v[4:5]
  s_waitcnt lgkmcnt(4)
  v_pk_add_f32 v[0:1], v[0:1], v[6:7]
  s_waitcnt lgkmcnt(3)
  v_pk_add_f32 v[0:1], v[0:1], v[8:9]
  s_waitcnt lgkmcnt(2)
  v_pk_add_f32 v[0:1], v[0:1], v[10:11]
  s_waitcnt lgkmcnt(1)
  v_pk_add_f32 v[0:1], v[0:1], v[12:13]
  s_waitcnt lgkmcnt(0)
  v_pk_add_f32 v[0:1], v[0:1], v[14:15]
  v_cvt_pk_bf16_f32 v0, v0, v1
  v_min_u32 v0, 0xfffffffe, v0
  s_cmp_eq_u32 s51, 0
  s_cbranch_scc1 SL_28
  buffer_store_dword v0, v31, s[24:27], s76 offen
  s_branch SE_29
SL_28:
  buffer_store_dword v0, v31, s[24:27], s76 offen sc1
SE_29:
OF_27:
  s_cmp_eq_u32 s49, 4
  s_cbranch_scc1 C_m2
  s_cmp_eq_u32 s49, 3
  s_cbranch_scc1 C_m1
  s_cmp_eq_u32 s49, 2
  s_cbranch_scc1 C_wo
  s_cmp_lg_u32 s52, 0
  s_cbranch_scc1 L_fin
  s_cmp_eq_u32 s49, 1
  s_cbranch_scc1 C_q
  s_branch C_qp
C_wo:
  v_mbcnt_lo_u32_b32 v24, -1, 0
  v_mbcnt_hi_u32_b32 v24, -1, v24
  v_and_b32 v25, 15, v24
  v_lshrrev_b32 v26, 4, v24
  v_and_b32 v27, 7, v25
  v_lshrrev_b32 v28, 3, v25
  v_mul_u32_u24 v27, 1040, v27
  v_mul_u32_u24 v28, 512, v28
  v_lshl_add_u32 v27, v26, 4, v27
  v_add_u32 v27, v27, v28
  s_mul_i32 s56, s44, 20480
  s_lshl_b32 s57, s50, 3
  s_add_u32 s57, s57, s48
  s_lshl_b32 s57, s57, 8
  s_add_u32 s56, s56, s57
  s_lshr_b32 s57, s56, 13
  s_lshl_b32 s57, s57, 14
  s_and_b32 s56, s56, 8191
  s_add_u32 s56, s56, s57
  s_add_u32 s56, s56, s52
  s_add_u32 s56, s56, 0
  s_add_u32 s77, s56, s54
  s_xor_b32 s76, s77, 8192
  v_lshlrev_b32 v29, 5, v25
  v_lshl_add_u32 v29, v26, 4, v29
  v_lshlrev_b32 v30, 4, v24
  s_lshl_b32 s56, s44, 13
  s_lshl_b32 s57, s48, 10
  s_add_u32 s56, s56, s57
  s_add_u32 s56, s56, s52
  s_add_u32 s59, s56, 327680
  s_mul_i32 s56, s48, 1040
  v_add_u32 v28, s56, v30
P_30:
  buffer_load_dwordx4 v[0:3], v30, s[24:27], s59 offen sc1
  s_waitcnt vmcnt(0)
  v_max3_u32 v31, v0, v1, v2
  v_max_u32 v31, v31, v3
  v_cmp_eq_u32 vcc, -1, v31
  s_cmp_eq_u64 vcc, 0
  s_cbranch_scc1 PD_31
  s_add_u32 s53, s53, 1
  s_cmp_lt_u32 s53, 400000
  s_cbranch_scc1 P_30
PD_31:
  ds_write_b128 v28, v[0:3] offset:0
  s_waitcnt lgkmcnt(0)
  s_barrier
  s_waitcnt vmcnt(0)
  ds_read_b128 v[4:7], v27 offset:0
  ds_read_b128 v[8:11], v27 offset:64
  ds_read_b128 v[12:15], v27 offset:128
  ds_read_b128 v[16:19], v27 offset:192
  ds_read_b128 v[20:23], v27 offset:256
  s_waitcnt lgkmcnt(4)
  v_mfma_f32_16x16x32_bf16 v[0:3], v[216:219], v[4:7], 0
  ds_read_b128 v[4:7], v27 offset:320
  s_waitcnt lgkmcnt(4)
  v_mfma_f32_16x16x32_bf16 v[0:3], v[220:223], v[8:11], v[0:3]
  ds_read_b128 v[8:11], v27 offset:384
  s_waitcnt lgkmcnt(4)
  v_mfma_f32_16x16x32_bf16 v[0:3], v[224:227], v[12:15], v[0:3]
  ds_read_b128 v[12:15], v27 offset:448
  s_waitcnt lgkmcnt(4)
  v_mfma_f32_16x16x32_bf16 v[0:3], v[228:231], v[16:19], v[0:3]
  s_waitcnt lgkmcnt(3)
  v_mfma_f32_16x16x32_bf16 v[0:3], v[232:235], v[20:23], v[0:3]
  s_waitcnt lgkmcnt(2)
  v_mfma_f32_16x16x32_bf16 v[0:3], v[236:239], v[4:7], v[0:3]
  s_waitcnt lgkmcnt(1)
  v_mfma_f32_16x16x32_bf16 v[0:3], v[240:243], v[8:11], v[0:3]
  s_waitcnt lgkmcnt(0)
  v_mfma_f32_16x16x32_bf16 v[0:3], v[244:247], v[12:15], v[0:3]
  s_nop 7
  s_nop 0
  v_mov_b32_dpp v4, v0 row_ror:8 row_mask:0xf bank_mask:0xf
  v_mov_b32_dpp v5, v1 row_ror:8 row_mask:0xf bank_mask:0xf
  v_mov_b32_dpp v6, v2 row_ror:8 row_mask:0xf bank_mask:0xf
  v_mov_b32_dpp v7, v3 row_ror:8 row_mask:0xf bank_mask:0xf
  s_nop 0
  v_permlane32_swap_b32 v4, v8
  v_permlane32_swap_b32 v5, v9
  v_permlane32_swap_b32 v6, v10
  v_permlane32_swap_b32 v7, v11
  s_nop 0
  v_add_f32 v0, v0, v8
  v_add_f32 v1, v1, v9
  v_add_f32 v2, v2, v10
  v_add_f32 v3, v3, v11
  v_min_u32 v0, 0xfffffffe, v0
  v_min_u32 v1, 0xfffffffe, v1
  v_min_u32 v2, 0xfffffffe, v2
  v_min_u32 v3, 0xfffffffe, v3
  s_mov_b32 exec_lo, 0x00ff00ff
  s_mov_b32 exec_hi, 0
  buffer_store_dwordx4 v[0:3], v29, s[24:27], s76 offen sc1
  buffer_store_dwordx4 v[0:3], v29, s[24:27], s77 offen sc1
  s_mov_b64 exec, -1
  s_cmp_lg_u32 s52, 0
  s_cbranch_scc1 L_fin
  s_branch C_qp
C_m1:
  v_mbcnt_lo_u32_b32 v24, -1, 0
  v_mbcnt_hi_u32_b32 v24, -1, v24
  v_and_b32 v25, 15, v24
  v_lshrrev_b32 v26, 4, v24
  v_and_b32 v27, 7, v25
  v_lshrrev_b32 v28, 3, v25
  v_mul_u32_u24 v27, 1296, v27
  v_mul_u32_u24 v28, 640, v28
  v_lshl_add_u32 v27, v26, 4, v27
  v_add_u32 v27, v27, v28
  s_lshl_b32 s56, s44, 12
  s_lshl_b32 s57, s50, 3
  s_add_u32 s57, s57, s48
  s_lshl_b32 s57, s57, 7
  s_add_u32 s56, s56, s57
  s_add_u32 s56, s56, s52
  s_add_u32 s76, s56, 557056
  v_lshlrev_b32 v29, 4, v25
  v_lshl_add_u32 v29, v26, 3, v29
  v_and_b32 v28, 1, v26
  v_lshlrev_b32 v28, 4, v28
  s_lshl_b32 s56, s48, 5
  v_add_u32 v28, s56, v28
  v_lshlrev_b32 v30, 2, v24
  s_mul_i32 s59, s44, 10240
  s_mul_i32 s57, s48, 1280
  s_add_u32 s59, s59, s57
  s_add_u32 s59, s59, s52
  s_add_u32 s59, s59, 393216
P_32:
  buffer_load_dword v0, v30, s[24:27], s59 offen offset:0 sc1
  buffer_load_dword v1, v30, s[24:27], s59 offen offset:256 sc1
  buffer_load_dword v2, v30, s[24:27], s59 offen offset:512 sc1
  buffer_load_dword v3, v30, s[24:27], s59 offen offset:768 sc1
  buffer_load_dword v4, v30, s[24:27], s59 offen offset:1024 sc1
  s_waitcnt vmcnt(0)
  v_max3_u32 v31, v0, v1, v2
  v_max3_u32 v31, v31, v3, v4
  v_cmp_eq_u32 vcc, -1, v31
  s_cmp_eq_u64 vcc, 0
  s_cbranch_scc1 PD_33
  s_add_u32 s53, s53, 1
  s_cmp_lt_u32 s53, 400000
  s_cbranch_scc1 P_32
PD_33:
  v_readfirstlane_b32 s56, v0
  s_lshl_b32 s56, s56, 16
  s_xor_b32 s57, s56, 0x80000000
  v_mov_b32 v20, s57
  v_dot2_f32_bf16 v6, v0, s5, v20
  v_dot2_f32_bf16 v7, v0, s6, v20
  v_dot2_f32_bf16 v8, v1, s5, v20
  v_dot2_f32_bf16 v9, v1, s6, v20
  v_dot2_f32_bf16 v10, v2, s5, v20
  v_dot2_f32_bf16 v11, v2, s6, v20
  v_dot2_f32_bf16 v12, v3, s5, v20
  v_dot2_f32_bf16 v13, v3, s6, v20
  v_dot2_f32_bf16 v14, v4, s5, v20
  v_dot2_f32_bf16 v15, v4, s6, v20
  v_pk_add_f32 v[16:17], v[6:7], v[8:9]
  v_pk_mul_f32 v[18:19], v[6:7], v[6:7]
  v_pk_fma_f32 v[18:19], v[8:9], v[8:9], v[18:19]
  v_pk_add_f32 v[16:17], v[10:11], v[16:17]
  v_pk_fma_f32 v[18:19], v[10:11], v[10:11], v[18:19]
  v_pk_add_f32 v[16:17], v[12:13], v[16:17]
  v_pk_fma_f32 v[18:19], v[12:13], v[12:13], v[18:19]
  v_pk_add_f32 v[16:17], v[14:15], v[16:17]
  v_pk_fma_f32 v[18:19], v[14:15], v[14:15], v[18:19]
  v_add_f32 v16, v16, v17
  v_add_f32 v18, v18, v19
  s_nop 0
  v_add_f32_dpp v16, v16, v16 row_shr:1 row_mask:0xf bank_mask:0xf
  v_add_f32_dpp v18, v18, v18 row_shr:1 row_mask:0xf bank_mask:0xf
  s_nop 0
  v_add_f32_dpp v16, v16, v16 row_shr:2 row_mask:0xf bank_mask:0xf
  v_add_f32_dpp v18, v18, v18 row_shr:2 row_mask:0xf bank_mask:0xf
  s_nop 0
  v_add_f32_dpp v16, v16, v16 row_shr:4 row_mask:0xf bank_mask:0xf
  v_add_f32_dpp v18, v18, v18 row_shr:4 row_mask:0xf bank_mask:0xf
  s_nop 0
  v_add_f32_dpp v16, v16, v16 row_shr:8 row_mask:0xf bank_mask:0xf
  v_add_f32_dpp v18, v18, v18 row_shr:8 row_mask:0xf bank_mask:0xf
  s_nop 0
  v_add_f32_dpp v16, v16, v16 row_bcast:15 row_mask:0xa bank_mask:0xf
  v_add_f32_dpp v18, v18, v18 row_bcast:15 row_mask:0xa bank_mask:0xf
  s_nop 0
  v_add_f32_dpp v16, v16, v16 row_bcast:31 row_mask:0xc bank_mask:0xf
  v_add_f32_dpp v18, v18, v18 row_bcast:31 row_mask:0xc bank_mask:0xf
  s_nop 1
  v_readlane_b32 s57, v16, 63
  v_readlane_b32 s58, v18, 63
  v_mov_b32 v20, 0x3acccccd
  s_nop 0
  v_mul_f32 v16, s57, v20
  v_mul_f32 v18, s58, v20
  v_fma_f32 v18, -v16, v16, v18
  v_add_f32 v16, s56, v16
  v_max_f32 v18, 0, v18
  v_cvt_pk_bf16_f32 v20, v16, v18
  v_and_b32 v18, 0xffff0000, v20
  v_add_f32 v18, 0x37280000, v18
  v_lshlrev_b32 v16, 16, v20
  v_cvt_pk_bf16_f32 v18, v18, v18
  v_and_b32 v18, 0xffff0000, v18
  v_sqrt_f32 v18, v18
  v_sub_f32 v16, s56, v16
  v_cvt_pk_bf16_f32 v18, v18, v18
  v_and_b32 v18, 0xffff0000, v18
  v_rcp_f32 v18, v18
  v_pk_add_f32 v[6:7], v[6:7], v[16:17] op_sel_hi:[1,0]
  v_pk_add_f32 v[8:9], v[8:9], v[16:17] op_sel_hi:[1,0]
  v_pk_add_f32 v[10:11], v[10:11], v[16:17] op_sel_hi:[1,0]
  v_pk_add_f32 v[12:13], v[12:13], v[16:17] op_sel_hi:[1,0]
  v_pk_add_f32 v[14:15], v[14:15], v[16:17] op_sel_hi:[1,0]
  v_cvt_pk_bf16_f32 v0, v6, v7
  v_cvt_pk_bf16_f32 v1, v8, v9
  v_cvt_pk_bf16_f32 v2, v10, v11
  v_cvt_pk_bf16_f32 v3, v12, v13
  v_cvt_pk_bf16_f32 v4, v14, v15
  v_lshlrev_b32 v6, 16, v0
  v_and_b32 v7, 0xffff0000, v0
  v_lshlrev_b32 v8, 16, v1
  v_and_b32 v9, 0xffff0000, v1
  v_lshlrev_b32 v10, 16, v2
  v_and_b32 v11, 0xffff0000, v2
  v_lshlrev_b32 v12, 16, v3
  v_and_b32 v13, 0xffff0000, v3
  v_lshlrev_b32 v14, 16, v4
  v_and_b32 v15, 0xffff0000, v4
  v_pk_mul_f32 v[6:7], v[6:7], v[18:19] op_sel_hi:[1,0]
  v_pk_mul_f32 v[8:9], v[8:9], v[18:19] op_sel_hi:[1,0]
  v_pk_mul_f32 v[10:11], v[10:11], v[18:19] op_sel_hi:[1,0]
  v_pk_mul_f32 v[12:13], v[12:13], v[18:19] op_sel_hi:[1,0]
  v_pk_mul_f32 v[14:15], v[14:15], v[18:19] op_sel_hi:[1,0]
  v_cvt_pk_bf16_f32 v0, v6, v7
  v_cvt_pk_bf16_f32 v1, v8, v9
  v_cvt_pk_bf16_f32 v2, v10, v11
  v_cvt_pk_bf16_f32 v3, v12, v13
  v_cvt_pk_bf16_f32 v4, v14, v15
  v_dot2_f32_bf16 v16, v0, s4, 0
  v_dot2_f32_bf16 v18, v0, v0, 0
  v_dot2_f32_bf16 v16, v1, s4, v16
  v_dot2_f32_bf16 v18, v1, v1, v18
  v_dot2_f32_bf16 v16, v2, s4, v16
  v_dot2_f32_bf16 v18, v2, v2, v18
  v_dot2_f32_bf16 v16, v3, s4, v16
  v_dot2_f32_bf16 v18, v3, v3, v18
  v_dot2_f32_bf16 v16, v4, s4, v16
  v_dot2_f32_bf16 v18, v4, v4, v18
  s_nop 1
  s_nop 0
  v_add_f32_dpp v16, v16, v16 row_shr:1 row_mask:0xf bank_mask:0xf
  v_add_f32_dpp v18, v18, v18 row_shr:1 row_mask:0xf bank_mask:0xf
  s_nop 0
  v_add_f32_dpp v16, v16, v16 row_shr:2 row_mask:0xf bank_mask:0xf
  v_add_f32_dpp v18, v18, v18 row_shr:2 row_mask:0xf bank_mask:0xf
  s_nop 0
  v_add_f32_dpp v16, v16, v16 row_shr:4 row_mask:0xf bank_mask:0xf
  v_add_f32_dpp v18, v18, v18 row_shr:4 row_mask:0xf bank_mask:0xf
  s_nop 0
  v_add_f32_dpp v16, v16, v16 row_shr:8 row_mask:0xf bank_mask:0xf
  v_add_f32_dpp v18, v18, v18 row_shr:8 row_mask:0xf bank_mask:0xf
  s_nop 0
  v_add_f32_dpp v16, v16, v16 row_bcast:15 row_mask:0xa bank_mask:0xf
  v_add_f32_dpp v18, v18, v18 row_bcast:15 row_mask:0xa bank_mask:0xf
  s_nop 0
  v_add_f32_dpp v16, v16, v16 row_bcast:31 row_mask:0xc bank_mask:0xf
  v_add_f32_dpp v18, v18, v18 row_bcast:31 row_mask:0xc bank_mask:0xf
  s_nop 1
  v_readlane_b32 s57, v16, 63
  v_readlane_b32 s58, v18, 63
  v_mov_b32 v20, 0x3acccccd
  s_nop 0
  v_mul_f32 v16, s57, v20
  v_mul_f32 v18, s58, v20
  v_fma_f32 v18, -v16, v16, v18
  v_max_f32 v18, 0, v18
  v_cvt_pk_bf16_f32 v20, v16, v18
  v_and_b32 v18, 0xffff0000, v20
  v_add_f32 v18, 0x37280000, v18
  v_lshlrev_b32 v16, 16, v20
  v_cvt_pk_bf16_f32 v18, v18, v18
  v_and_b32 v18, 0xffff0000, v18
  v_sqrt_f32 v18, v18
  v_sub_f32 v16, 0, v16
  v_cvt_pk_bf16_f32 v18, v18, v18
  v_and_b32 v18, 0xffff0000, v18
  v_rcp_f32 v18, v18
  v_dot2_f32_bf16 v6, v0, s5, v16
  v_dot2_f32_bf16 v7, v0, s6, v16
  v_dot2_f32_bf16 v8, v1, s5, v16
  v_dot2_f32_bf16 v9, v1, s6, v16
  v_dot2_f32_bf16 v10, v2, s5, v16
  v_dot2_f32_bf16 v11, v2, s6, v16
  v_dot2_f32_bf16 v12, v3, s5, v16
  v_dot2_f32_bf16 v13, v3, s6, v16
  v_dot2_f32_bf16 v14, v4, s5, v16
  v_dot2_f32_bf16 v15, v4, s6, v16
  v_cvt_pk_bf16_f32 v0, v6, v7
  v_cvt_pk_bf16_f32 v1, v8, v9
  v_cvt_pk_bf16_f32 v2, v10, v11
  v_cvt_pk_bf16_f32 v3, v12, v13
  v_cvt_pk_bf16_f32 v4, v14, v15
  v_lshlrev_b32 v6, 16, v0
  v_and_b32 v7, 0xffff0000, v0
  v_lshlrev_b32 v8, 16, v1
  v_and_b32 v9, 0xffff0000, v1
  v_lshlrev_b32 v10, 16, v2
  v_and_b32 v11, 0xffff0000, v2
  v_lshlrev_b32 v12, 16, v3
  v_and_b32 v13, 0xffff0000, v3
  v_lshlrev_b32 v14, 16, v4
  v_and_b32 v15, 0xffff0000, v4
  v_pk_mul_f32 v[6:7], v[6:7], v[18:19] op_sel_hi:[1,0]
  v_pk_mul_f32 v[8:9], v[8:9], v[18:19] op_sel_hi:[1,0]
  v_pk_mul_f32 v[10:11], v[10:11], v[18:19] op_sel_hi:[1,0]
  v_pk_mul_f32 v[12:13], v[12:13], v[18:19] op_sel_hi:[1,0]
  v_pk_mul_f32 v[14:15], v[14:15], v[18:19] op_sel_hi:[1,0]
  v_cvt_pk_bf16_f32 v0, v6, v7
  v_cvt_pk_bf16_f32 v1, v8, v9
  v_cvt_pk_bf16_f32 v2, v10, v11
  v_cvt_pk_bf16_f32 v3, v12, v13
  v_cvt_pk_bf16_f32 v4, v14, v15
  s_mul_i32 s56, s48, 1296
  v_add_u32 v30, s56, v30
  ds_write_b32 v30, v0 offset:0
  ds_write_b32 v30, v1 offset:256
  ds_write_b32 v30, v2 offset:512
  ds_write_b32 v30, v3 offset:768
  ds_write_b32 v30, v4 offset:1024
  s_waitcnt lgkmcnt(0)
  ds_read_b128 v[20:23], v28 offset:14464
  s_barrier
  ds_read_b128 v[4:7], v27 offset:0
  ds_read_b128 v[8:11], v27 offset:64
  ds_read_b128 v[12:15], v27 offset:128
  ds_read_b128 v[16:19], v27 offset:192
  s_waitcnt lgkmcnt(3)
  v_mfma_f32_16x16x32_bf16 v[0:3], v[216:219], v[4:7], 0
  ds_read_b128 v[4:7], v27 offset:256
  s_waitcnt lgkmcnt(3)
  v_mfma_f32_16x16x32_bf16 v[0:3], v[220:223], v[8:11], v[0:3]
  ds_read_b128 v[8:11], v27 offset:320
  s_waitcnt lgkmcnt(3)
  v_mfma_f32_16x16x32_bf16 v[0:3], v[224:227], v[12:15], v[0:3]
  ds_read_b128 v[12:15], v27 offset:384
  s_waitcnt lgkmcnt(3)
  v_mfma_f32_16x16x32_bf16 v[0:3], v[228:231], v[16:19], v[0:3]
  ds_read_b128 v[16:19], v27 offset:448
  s_waitcnt lgkmcnt(3)
  v_mfma_f32_16x16x32_bf16 v[0:3], v[232:235], v[4:7], v[0:3]
  ds_read_b128 v[4:7], v27 offset:512
  s_waitcnt lgkmcnt(3)
  v_mfma_f32_16x16x32_bf16 v[0:3], v[236:239], v[8:11], v[0:3]
  ds_read_b128 v[8:11], v27 offset:576
  s_waitcnt lgkmcnt(3)
  v_mfma_f32_16x16x32_bf16 v[0:3], v[240:243], v[12:15], v[0:3]
  s_waitcnt lgkmcnt(2)
  v_mfma_f32_16x16x32_bf16 v[0:3], v[244:247], v[16:19], v[0:3]
  s_waitcnt lgkmcnt(1)
  v_mfma_f32_16x16x32_bf16 v[0:3], v[248:251], v[4:7], v[0:3]
  s_waitcnt lgkmcnt(0)
  v_mfma_f32_16x16x32_bf16 v[0:3], v[252:255], v[8:11], v[0:3]
  s_nop 7
  s_nop 0
  v_mov_b32_dpp v4, v0 row_ror:8 row_mask:0xf bank_mask:0xf
  v_mov_b32_dpp v5, v1 row_ror:8 row_mask:0xf bank_mask:0xf
  v_mov_b32_dpp v6, v2 row_ror:8 row_mask:0xf bank_mask:0xf
  v_mov_b32_dpp v7, v3 row_ror:8 row_mask:0xf bank_mask:0xf
  s_nop 0
  v_permlane32_swap_b32 v4, v8
  v_permlane32_swap_b32 v5, v9
  v_permlane32_swap_b32 v6, v10
  v_permlane32_swap_b32 v7, v11
  s_nop 0
  v_add_f32 v0, v0, v8
  v_add_f32 v1, v1, v9
  v_add_f32 v2, v2, v10
  v_add_f32 v3, v3, v11
  v_cvt_pk_bf16_f32 v4, v0, v1
  v_cvt_pk_bf16_f32 v5, v2, v3
  v_lshlrev_b32 v0, 16, v4
  v_and_b32 v1, 0xffff0000, v4
  v_lshlrev_b32 v2, 16, v5
  v_and_b32 v3, 0xffff0000, v5
  v_add_f32 v0, v0, v20
  v_add_f32 v1, v1, v21
  v_add_f32 v2, v2, v22
  v_add_f32 v3, v3, v23
  v_cvt_pk_bf16_f32 v4, v0, v1
  v_cvt_pk_bf16_f32 v5, v2, v3
  v_lshlrev_b32 v0, 16, v4
  v_and_b32 v1, 0xffff0000, v4
  v_lshlrev_b32 v2, 16, v5
  v_and_b32 v3, 0xffff0000, v5
  v_mov_b32 v12, 0x3dd2d3e8
  v_mov_b32 v13, 0x40135761
  v_mul_f32 v4, v0, v0
  v_mul_f32 v5, v1, v1
  v_mul_f32 v6, v2, v2
  v_mul_f32 v7, v3, v3
  v_fma_f32 v4, v4, v12, v13
  v_fma_f32 v5, v5, v12, v13
  v_fma_f32 v6, v6, v12, v13
  v_fma_f32 v7, v7, v12, v13
  v_mul_f32 v4, v4, v0
  v_mul_f32 v5, v5, v1
  v_mul_f32 v6, v6, v2
  v_mul_f32 v7, v7, v3
  v_exp_f32 v4, -v4
  v_exp_f32 v5, -v5
  v_exp_f32 v6, -v6
  v_exp_f32 v7, -v7
  s_nop 0
  v_add_f32 v4, 1.0, v4
  v_add_f32 v5, 1.0, v5
  v_add_f32 v6, 1.0, v6
  v_add_f32 v7, 1.0, v7
  v_rcp_f32 v4, v4
  v_rcp_f32 v5, v5
  v_rcp_f32 v6, v6
  v_rcp_f32 v7, v7
  s_nop 0
  v_mul_f32 v0, v0, v4
  v_mul_f32 v1, v1, v5
  v_mul_f32 v2, v2, v6
  v_mul_f32 v3, v3, v7
  v_cvt_pk_bf16_f32 v4, v0, v1
  v_cvt_pk_bf16_f32 v5, v2, v3
  v_min_u32 v4, 0xfffffffe, v4
  v_min_u32 v5, 0xfffffffe, v5
  s_mov_b32 exec_lo, 0x00ff00ff
  s_mov_b32 exec_hi, 0
  s_cmp_eq_u32 s51, 0
  s_cbranch_scc1 SL_34
  buffer_store_dwordx2 v[4:5], v29, s[24:27], s76 offen
  s_branch SE_35
SL_34:
  buffer_store_dwordx2 v[4:5], v29, s[24:27], s76 offen sc1
SE_35:
  s_mov_b64 exec, -1
  s_cmp_lg_u32 s52, 0
  s_cbranch_scc1 L_fin
  s_branch C_qp
C_m2:
  v_mbcnt_lo_u32_b32 v10, -1, 0
  v_mbcnt_hi_u32_b32 v10, -1, v10
  v_lshlrev_b32 v11, 2, v10
  s_lshl_b32 s58, s50, 3
  s_add_u32 s58, s58, s48
  s_lshl_b32 s59, s58, 8
  s_add_u32 s76, s52, s54
  s_add_u32 s76, s76, 0
  s_add_u32 s56, s59, 0
  s_lshr_b32 s57, s56, 13
  s_lshl_b32 s57, s57, 14
  s_and_b32 s56, s56, 8191
  s_add_u32 s56, s56, s57
  s_add_u32 s66, s56, s76
  s_add_u32 s56, s59, 20480
  s_lshr_b32 s57, s56, 13
  s_lshl_b32 s57, s57, 14
  s_and_b32 s56, s56, 8191
  s_add_u32 s56, s56, s57
  s_add_u32 s67, s56, s76
  s_add_u32 s56, s59, 40960
  s_lshr_b32 s57, s56, 13
  s_lshl_b32 s57, s57, 14
  s_and_b32 s56, s56, 8191
  s_add_u32 s56, s56, s57
  s_add_u32 s68, s56, s76
  s_add_u32 s56, s59, 61440
  s_lshr_b32 s57, s56, 13
  s_lshl_b32 s57, s57, 14
  s_and_b32 s56, s56, 8191
  s_add_u32 s56, s56, s57
  s_add_u32 s69, s56, s76
  s_add_u32 s56, s59, 81920
  s_lshr_b32 s57, s56, 13
  s_lshl_b32 s57, s57, 14
  s_and_b32 s56, s56, 8191
  s_add_u32 s56, s56, s57
  s_add_u32 s70, s56, s76
  s_add_u32 s56, s59, 102400
  s_lshr_b32 s57, s56, 13
  s_lshl_b32 s57, s57, 14
  s_and_b32 s56, s56, 8191
  s_add_u32 s56, s56, s57
  s_add_u32 s71, s56, s76
  s_add_u32 s56, s59, 122880
  s_lshr_b32 s57, s56, 13
  s_lshl_b32 s57, s57, 14
  s_and_b32 s56, s56, 8191
  s_add_u32 s56, s56, s57
  s_add_u32 s72, s56, s76
  s_add_u32 s56, s59, 143360
  s_lshr_b32 s57, s56, 13
  s_lshl_b32 s57, s57, 14
  s_and_b32 s56, s56, 8191
  s_add_u32 s56, s56, s57
  s_add_u32 s73, s56, s76
  v_and_b32 v16, 7, v10
  v_lshlrev_b32 v16, 1, v16
  v_lshrrev_b32 v17, 3, v10
  v_mul_u32_u24 v17, 1280, v17
  v_add_u32 v17, v17, v16
  s_mul_i32 s76, s44, 10240
  s_lshl_b32 s57, s58, 4
  s_add_u32 s76, s76, s57
  s_add_u32 s76, s76, s52
  s_add_u32 s76, s76, 393216
  s_mov_b32 s60, 0x55555555
  s_mov_b32 s61, 0x55555555
P_36:
  buffer_load_dword v0, v11, s[24:27], s66 offen sc1
  buffer_load_dword v1, v11, s[24:27], s67 offen sc1
  buffer_load_dword v2, v11, s[24:27], s68 offen sc1
  buffer_load_dword v3, v11, s[24:27], s69 offen sc1
  buffer_load_dword v4, v11, s[24:27], s70 offen sc1
  buffer_load_dword v5, v11, s[24:27], s71 offen sc1
  buffer_load_dword v6, v11, s[24:27], s72 offen sc1
  buffer_load_dword v7, v11, s[24:27], s73 offen sc1
  s_waitcnt vmcnt(0)
  v_max3_u32 v31, v0, v1, v2
  v_max3_u32 v31, v31, v3, v4
  v_max3_u32 v31, v31, v5, v6
  v_max_u32 v31, v31, v7
  v_cmp_eq_u32 vcc, -1, v31
  s_cmp_eq_u64 vcc, 0
  s_cbranch_scc1 PD_37
  s_add_u32 s53, s53, 1
  s_cmp_lt_u32 s53, 400000
  s_cbranch_scc1 P_36
PD_37:
  v_add_f32 v8, v0, v1
  v_add_f32 v9, v2, v3
  v_add_f32 v12, v4, v5
  v_add_f32 v13, v6, v7
  v_add_f32 v8, v8, v9
  v_add_f32 v12, v12, v13
  v_add_f32 v8, v8, v12
  v_cvt_pk_bf16_f32 v8, v8, v8
  v_and_b32 v8, 0xffff0000, v8
  v_add_f32 v8, v8, v248
  v_cvt_pk_bf16_f32 v8, v8, v8
  v_and_b32 v248, 0xffff0000, v8
  v_and_b32 v9, 0xffff, v8
  s_nop 0
  v_or_b32_dpp v9, v248, v9 quad_perm:[1,1,3,3] row_mask:0xf bank_mask:0xf
  s_and_b64 exec, exec, s[60:61]
  v_min_u32 v9, 0xfffffffe, v9
  s_cmp_eq_u32 s51, 0
  s_cbranch_scc1 SL_38
  buffer_store_dword v9, v17, s[24:27], s76 offen
  s_branch SE_39
SL_38:
  buffer_store_dword v9, v17, s[24:27], s76 offen sc1
SE_39:
  s_mov_b64 exec, -1
  s_waitcnt vmcnt(1)
  v_mbcnt_lo_u32_b32 v24, -1, 0
  v_mbcnt_hi_u32_b32 v24, -1, v24
  v_and_b32 v25, 15, v24
  v_lshrrev_b32 v26, 4, v24
  v_and_b32 v27, 7, v25
  v_lshrrev_b32 v28, 3, v25
  v_mul_u32_u24 v27, 528, v27
  v_lshl_add_u32 v27, v26, 4, v27
  s_lshl_b32 s56, s55, 6
  v_mul_u32_u24 v28, s56, v28
  v_add_u32 v27, v27, v28
  s_mul_i32 s56, s44, 20480
  s_lshl_b32 s57, s50, 3
  s_add_u32 s57, s57, s48
  s_lshl_b32 s57, s57, 8
  s_add_u32 s56, s56, s57
  s_lshr_b32 s57, s56, 13
  s_lshl_b32 s57, s57, 14
  s_and_b32 s56, s56, 8191
  s_add_u32 s56, s56, s57
  s_add_u32 s56, s56, s52
  s_add_u32 s56, s56, 655360
  s_add_u32 s77, s56, s54
  s_xor_b32 s76, s77, 8192
  v_lshlrev_b32 v29, 5, v25
  v_lshl_add_u32 v29, v26, 4, v29
  v_lshlrev_b32 v30, 3, v24
  v_bfe_u32 v28, v24, 1, 3
  v_mul_u32_u24 v28, 528, v28
  v_lshl_add_u32 v28, v26, 4, v28
  v_and_b32 v23, 1, v24
  v_lshl_add_u32 v28, v23, 3, v28
  s_lshl_b32 s56, s48, 6
  v_add_u32 v28, s56, v28
  s_lshl_b32 s56, s44, 12
  s_lshl_b32 s57, s48, 9
  s_add_u32 s56, s56, s57
  s_add_u32 s56, s56, s52
  s_add_u32 s59, s56, 557056
  s_lshl_b32 s56, s55, 1
  s_cmp_ge_u32 s48, s56
  s_cbranch_scc1 M2s_40
P_41:
  buffer_load_dwordx2 v[0:1], v30, s[24:27], s59 offen sc1
  s_waitcnt vmcnt(0)
  v_max_u32 v31, v0, v1
  v_cmp_eq_u32 vcc, -1, v31
  s_cmp_eq_u64 vcc, 0
  s_cbranch_scc1 PD_42
  s_add_u32 s53, s53, 1
  s_cmp_lt_u32 s53, 400000
  s_cbranch_scc1 P_41
PD_42:
  ds_write_b64 v28, v[0:1] offset:0
  s_waitcnt lgkmcnt(0)
M2s_40:
  s_barrier
  ds_read_b128 v[4:7], v27 offset:0
  ds_read_b128 v[8:11], v27 offset:64
  ds_read_b128 v[12:15], v27 offset:128
  ds_read_b128 v[16:19], v27 offset:192
  s_waitcnt vmcnt(0)
  s_waitcnt lgkmcnt(3)
  v_mfma_f32_16x16x32_bf16 v[0:3], v[216:219], v[4:7], 0
  s_waitcnt lgkmcnt(2)
  v_mfma_f32_16x16x32_bf16 v[0:3], v[220:223], v[8:11], v[0:3]
  s_waitcnt lgkmcnt(1)
  v_mfma_f32_16x16x32_bf16 v[0:3], v[224:227], v[12:15], v[0:3]
  s_cmp_eq_u32 s55, 3
  s_cbranch_scc1 M2c_43
  s_waitcnt lgkmcnt(0)
  v_mfma_f32_16x16x32_bf16 v[0:3], v[228:231], v[16:19], v[0:3]
M2c_43:
  s_waitcnt lgkmcnt(0)
  s_nop 7
  s_nop 0
  v_mov_b32_dpp v4, v0 row_ror:8 row_mask:0xf bank_mask:0xf
  v_mov_b32_dpp v5, v1 row_ror:8 row_mask:0xf bank_mask:0xf
  v_mov_b32_dpp v6, v2 row_ror:8 row_mask:0xf bank_mask:0xf
  v_mov_b32_dpp v7, v3 row_ror:8 row_mask:0xf bank_mask:0xf
  s_nop 0
  v_permlane32_swap_b32 v4, v8
  v_permlane32_swap_b32 v5, v9
  v_permlane32_swap_b32 v6, v10
  v_permlane32_swap_b32 v7, v11
  s_nop 0
  v_add_f32 v0, v0, v8
  v_add_f32 v1, v1, v9
  v_add_f32 v2, v2, v10
  v_add_f32 v3, v3, v11
  v_min_u32 v0, 0xfffffffe, v0
  v_min_u32 v1, 0xfffffffe, v1
  v_min_u32 v2, 0xfffffffe, v2
  v_min_u32 v3, 0xfffffffe, v3
  s_mov_b32 exec_lo, 0x00ff00ff
  s_mov_b32 exec_hi, 0
  buffer_store_dwordx4 v[0:3], v29, s[24:27], s76 offen sc1
  buffer_store_dwordx4 v[0:3], v29, s[24:27], s77 offen sc1
  s_mov_b64 exec, -1
  v_mbcnt_lo_u32_b32 v10, -1, 0
  v_mbcnt_hi_u32_b32 v10, -1, v10
  v_lshlrev_b32 v11, 2, v10
  s_lshl_b32 s58, s50, 3
  s_add_u32 s58, s58, s48
  s_lshl_b32 s59, s58, 8
  s_add_u32 s76, s52, s54
  s_add_u32 s76, s76, 655360
  s_add_u32 s56, s59, 0
  s_lshr_b32 s57, s56, 13
  s_lshl_b32 s57, s57, 14
  s_and_b32 s56, s56, 8191
  s_add_u32 s56, s56, s57
  s_add_u32 s66, s56, s76
  s_add_u32 s56, s59, 20480
  s_lshr_b32 s57, s56, 13
  s_lshl_b32 s57, s57, 14
  s_and_b32 s56, s56, 8191
  s_add_u32 s56, s56, s57
  s_add_u32 s67, s56, s76
  s_add_u32 s56, s59, 40960
  s_lshr_b32 s57, s56, 13
  s_lshl_b32 s57, s57, 14
  s_and_b32 s56, s56, 8191
  s_add_u32 s56, s56, s57
  s_add_u32 s68, s56, s76
  s_add_u32 s56, s59, 61440
  s_lshr_b32 s57, s56, 13
  s_lshl_b32 s57, s57, 14
  s_and_b32 s56, s56, 8191
  s_add_u32 s56, s56, s57
  s_add_u32 s69, s56, s76
  s_add_u32 s56, s59, 81920
  s_lshr_b32 s57, s56, 13
  s_lshl_b32 s57, s57, 14
  s_and_b32 s56, s56, 8191
  s_add_u32 s56, s56, s57
  s_add_u32 s70, s56, s76
  s_add_u32 s56, s59, 102400
  s_lshr_b32 s57, s56, 13
  s_lshl_b32 s57, s57, 14
  s_and_b32 s56, s56, 8191
  s_add_u32 s56, s56, s57
  s_add_u32 s71, s56, s76
  s_add_u32 s56, s59, 122880
  s_lshr_b32 s57, s56, 13
  s_lshl_b32 s57, s57, 14
  s_and_b32 s56, s56, 8191
  s_add_u32 s56, s56, s57
  s_add_u32 s72, s56, s76
  s_add_u32 s56, s59, 143360
  s_lshr_b32 s57, s56, 13
  s_lshl_b32 s57, s57, 14
  s_and_b32 s56, s56, 8191
  s_add_u32 s56, s56, s57
  s_add_u32 s73, s56, s76
  v_and_b32 v16, 7, v10
  v_lshlrev_b32 v16, 1, v16
  v_lshrrev_b32 v17, 3, v10
  v_mul_u32_u24 v17, 1280, v17
  v_add_u32 v17, v17, v16
  s_mul_i32 s76, s44, 10240
  s_lshl_b32 s57, s58, 4
  s_add_u32 s76, s76, s57
  s_add_u32 s76, s76, s52
  s_add_u32 s76, s76, 475136
  s_cmp_eq_u32 s52, 0
  s_cbranch_scc1 RF_44
  s_mul_i32 s76, s44, 1280
  s_add_u32 s76, s76, s57
  s_lshl_b32 s56, s44, 3
  s_lshl_b64 exec, 0xff, s56
RF_44:
  s_mov_b32 s60, 0x55555555
  s_mov_b32 s61, 0x55555555
P_45:
  buffer_load_dword v0, v11, s[24:27], s66 offen sc1
  buffer_load_dword v1, v11, s[24:27], s67 offen sc1
  buffer_load_dword v2, v11, s[24:27], s68 offen sc1
  buffer_load_dword v3, v11, s[24:27], s69 offen sc1
  buffer_load_dword v4, v11, s[24:27], s70 offen sc1
  buffer_load_dword v5, v11, s[24:27], s71 offen sc1
  buffer_load_dword v6, v11, s[24:27], s72 offen sc1
  buffer_load_dword v7, v11, s[24:27], s73 offen sc1
  s_waitcnt vmcnt(0)
  v_max3_u32 v31, v0, v1, v2
  v_max3_u32 v31, v31, v3, v4
  v_max3_u32 v31, v31, v5, v6
  v_max_u32 v31, v31, v7
  v_cmp_eq_u32 vcc, -1, v31
  s_cmp_eq_u64 vcc, 0
  s_cbranch_scc1 PD_46
  s_add_u32 s53, s53, 1
  s_cmp_lt_u32 s53, 400000
  s_cbranch_scc1 P_45
PD_46:
  v_add_f32 v8, v0, v1
  v_add_f32 v9, v2, v3
  v_add_f32 v12, v4, v5
  v_add_f32 v13, v6, v7
  v_add_f32 v8, v8, v9
  v_add_f32 v12, v12, v13
  v_add_f32 v8, v8, v12
  v_cvt_pk_bf16_f32 v8, v8, v8
  v_and_b32 v8, 0xffff0000, v8
  v_add_f32 v8, v8, v249
  v_cvt_pk_bf16_f32 v8, v8, v8
  v_and_b32 v8, 0xffff0000, v8
  v_add_f32 v8, v8, v248
  v_cvt_pk_bf16_f32 v8, v8, v8
  v_and_b32 v248, 0xffff0000, v8
  v_and_b32 v9, 0xffff, v8
  s_nop 0
  v_or_b32_dpp v9, v248, v9 quad_perm:[1,1,3,3] row_mask:0xf bank_mask:0xf
  s_and_b64 exec, exec, s[60:61]
  s_cmp_eq_u32 s52, 0
  s_cbranch_scc1 RO_47
  buffer_store_dword v9, v16, s[32:35], s76 offen
  s_branch ROE_48
RO_47:
  v_min_u32 v9, 0xfffffffe, v9
  s_cmp_eq_u32 s51, 0
  s_cbranch_scc1 SL_49
  buffer_store_dword v9, v17, s[24:27], s76 offen
  s_branch SE_50
SL_49:
  buffer_store_dword v9, v17, s[24:27], s76 offen sc1
SE_50:
ROE_48:
  s_mov_b64 exec, -1
  s_waitcnt vmcnt(1)
  s_cmp_lg_u32 s52, 0
  s_cbranch_scc1 L_fin
  s_branch C_qp
C_q:
  v_mbcnt_lo_u32_b32 v24, -1, 0
  v_mbcnt_hi_u32_b32 v24, -1, v24
  v_and_b32 v25, 15, v24
  v_lshrrev_b32 v26, 4, v24
  v_and_b32 v27, 7, v25
  v_lshrrev_b32 v28, 3, v25
  v_mul_u32_u24 v27, 1296, v27
  v_mul_u32_u24 v28, 640, v28
  v_lshl_add_u32 v27, v26, 4, v27
  v_add_u32 v27, v27, v28
  s_lshl_b32 s56, s44, 6
  s_lshl_b32 s57, s50, 3
  s_add_u32 s56, s56, s57
  s_add_u32 s56, s56, s48
  s_lshl_b32 s56, s56, 7
  s_add_u32 s76, s56, 1572864
  v_lshlrev_b32 v29, 4, v25
  v_lshl_add_u32 v29, v26, 3, v29
  v_lshlrev_b32 v30, 2, v24
  s_mul_i32 s59, s44, 10240
  s_mul_i32 s57, s48, 1280
  s_add_u32 s59, s59, s57
  s_add_u32 s59, s59, s52
  s_add_u32 s59, s59, 475136
P_51:
  buffer_load_dword v0, v30, s[24:27], s59 offen offset:0 sc1
  buffer_load_dword v1, v30, s[24:27], s59 offen offset:256 sc1
  buffer_load_dword v2, v30, s[24:27], s59 offen offset:512 sc1
  buffer_load_dword v3, v30, s[24:27], s59 offen offset:768 sc1
  buffer_load_dword v4, v30, s[24:27], s59 offen offset:1024 sc1
  s_waitcnt vmcnt(0)
  v_max3_u32 v31, v0, v1, v2
  v_max3_u32 v31, v31, v3, v4
  v_cmp_eq_u32 vcc, -1, v31
  s_cmp_eq_u64 vcc, 0
  s_cbranch_scc1 PD_52
  s_add_u32 s53, s53, 1
  s_cmp_lt_u32 s53, 400000
  s_cbranch_scc1 P_51
PD_52:
  v_readfirstlane_b32 s56, v0
  s_lshl_b32 s56, s56, 16
  s_xor_b32 s57, s56, 0x80000000
  v_mov_b32 v20, s57
  v_dot2_f32_bf16 v6, v0, s5, v20
  v_dot2_f32_bf16 v7, v0, s6, v20
  v_dot2_f32_bf16 v8, v1, s5, v20
  v_dot2_f32_bf16 v9, v1, s6, v20
  v_dot2_f32_bf16 v10, v2, s5, v20
  v_dot2_f32_bf16 v11, v2, s6, v20
  v_dot2_f32_bf16 v12, v3, s5, v20
  v_dot2_f32_bf16 v13, v3, s6, v20
  v_dot2_f32_bf16 v14, v4, s5, v20
  v_dot2_f32_bf16 v15, v4, s6, v20
  v_pk_add_f32 v[16:17], v[6:7], v[8:9]
  v_pk_mul_f32 v[18:19], v[6:7], v[6:7]
  v_pk_fma_f32 v[18:19], v[8:9], v[8:9], v[18:19]
  v_pk_add_f32 v[16:17], v[10:11], v[16:17]
  v_pk_fma_f32 v[18:19], v[10:11], v[10:11], v[18:19]
  v_pk_add_f32 v[16:17], v[12:13], v[16:17]
  v_pk_fma_f32 v[18:19], v[12:13], v[12:13], v[18:19]
  v_pk_add_f32 v[16:17], v[14:15], v[16:17]
  v_pk_fma_f32 v[18:19], v[14:15], v[14:15], v[18:19]
  v_add_f32 v16, v16, v17
  v_add_f32 v18, v18, v19
  s_nop 0
  v_add_f32_dpp v16, v16, v16 row_shr:1 row_mask:0xf bank_mask:0xf
  v_add_f32_dpp v18, v18, v18 row_shr:1 row_mask:0xf bank_mask:0xf
  s_nop 0
  v_add_f32_dpp v16, v16, v16 row_shr:2 row_mask:0xf bank_mask:0xf
  v_add_f32_dpp v18, v18, v18 row_shr:2 row_mask:0xf bank_mask:0xf
  s_nop 0
  v_add_f32_dpp v16, v16, v16 row_shr:4 row_mask:0xf bank_mask:0xf
  v_add_f32_dpp v18, v18, v18 row_shr:4 row_mask:0xf bank_mask:0xf
  s_nop 0
  v_add_f32_dpp v16, v16, v16 row_shr:8 row_mask:0xf bank_mask:0xf
  v_add_f32_dpp v18, v18, v18 row_shr:8 row_mask:0xf bank_mask:0xf
  s_nop 0
  v_add_f32_dpp v16, v16, v16 row_bcast:15 row_mask:0xa bank_mask:0xf
  v_add_f32_dpp v18, v18, v18 row_bcast:15 row_mask:0xa bank_mask:0xf
  s_nop 0
  v_add_f32_dpp v16, v16, v16 row_bcast:31 row_mask:0xc bank_mask:0xf
  v_add_f32_dpp v18, v18, v18 row_bcast:31 row_mask:0xc bank_mask:0xf
  s_nop 1
  v_readlane_b32 s57, v16, 63
  v_readlane_b32 s58, v18, 63
  v_mov_b32 v20, 0x3acccccd
  s_nop 0
  v_mul_f32 v16, s57, v20
  v_mul_f32 v18, s58, v20
  v_fma_f32 v18, -v16, v16, v18
  v_add_f32 v16, s56, v16
  v_max_f32 v18, 0, v18
  v_cvt_pk_bf16_f32 v20, v16, v18
  v_and_b32 v18, 0xffff0000, v20
  v_add_f32 v18, 0x37280000, v18
  v_lshlrev_b32 v16, 16, v20
  v_cvt_pk_bf16_f32 v18, v18, v18
  v_and_b32 v18, 0xffff0000, v18
  v_sqrt_f32 v18, v18
  v_sub_f32 v16, s56, v16
  v_cvt_pk_bf16_f32 v18, v18, v18
  v_and_b32 v18, 0xffff0000, v18
  v_rcp_f32 v18, v18
  v_pk_add_f32 v[6:7], v[6:7], v[16:17] op_sel_hi:[1,0]
  v_pk_add_f32 v[8:9], v[8:9], v[16:17] op_sel_hi:[1,0]
  v_pk_add_f32 v[10:11], v[10:11], v[16:17] op_sel_hi:[1,0]
  v_pk_add_f32 v[12:13], v[12:13], v[16:17] op_sel_hi:[1,0]
  v_pk_add_f32 v[14:15], v[14:15], v[16:17] op_sel_hi:[1,0]
  v_cvt_pk_bf16_f32 v0, v6, v7
  v_cvt_pk_bf16_f32 v1, v8, v9
  v_cvt_pk_bf16_f32 v2, v10, v11
  v_cvt_pk_bf16_f32 v3, v12, v13
  v_cvt_pk_bf16_f32 v4, v14, v15
  v_lshlrev_b32 v6, 16, v0
  v_and_b32 v7, 0xffff0000, v0
  v_lshlrev_b32 v8, 16, v1
  v_and_b32 v9, 0xffff0000, v1
  v_lshlrev_b32 v10, 16, v2
  v_and_b32 v11, 0xffff0000, v2
  v_lshlrev_b32 v12, 16, v3
  v_and_b32 v13, 0xffff0000, v3
  v_lshlrev_b32 v14, 16, v4
  v_and_b32 v15, 0xffff0000, v4
  v_pk_mul_f32 v[6:7], v[6:7], v[18:19] op_sel_hi:[1,0]
  v_pk_mul_f32 v[8:9], v[8:9], v[18:19] op_sel_hi:[1,0]
  v_pk_mul_f32 v[10:11], v[10:11], v[18:19] op_sel_hi:[1,0]
  v_pk_mul_f32 v[12:13], v[12:13], v[18:19] op_sel_hi:[1,0]
  v_pk_mul_f32 v[14:15], v[14:15], v[18:19] op_sel_hi:[1,0]
  v_cvt_pk_bf16_f32 v0, v6, v7
  v_cvt_pk_bf16_f32 v1, v8, v9
  v_cvt_pk_bf16_f32 v2, v10, v11
  v_cvt_pk_bf16_f32 v3, v12, v13
  v_cvt_pk_bf16_f32 v4, v14, v15
  s_mul_i32 s56, s48, 1296
  v_add_u32 v30, s56, v30
  ds_write_b32 v30, v0 offset:0
  ds_write_b32 v30, v1 offset:256
  ds_write_b32 v30, v2 offset:512
  ds_write_b32 v30, v3 offset:768
  ds_write_b32 v30, v4 offset:1024
  s_waitcnt lgkmcnt(0)
  s_barrier
  ds_read_b128 v[4:7], v27 offset:0
  ds_read_b128 v[8:11], v27 offset:64
  ds_read_b128 v[12:15], v27 offset:128
  ds_read_b128 v[16:19], v27 offset:192
  ds_read_b128 v[20:23], v27 offset:256
  s_waitcnt lgkmcnt(4)
  v_mfma_f32_16x16x32_bf16 v[0:3], v[216:219], v[4:7], 0
  ds_read_b128 v[4:7], v27 offset:320
  s_waitcnt lgkmcnt(4)
  v_mfma_f32_16x16x32_bf16 v[0:3], v[220:223], v[8:11], v[0:3]
  ds_read_b128 v[8:11], v27 offset:384
  s_waitcnt lgkmcnt(4)
  v_mfma_f32_16x16x32_bf16 v[0:3], v[224:227], v[12:15], v[0:3]
  ds_read_b128 v[12:15], v27 offset:448
  s_waitcnt lgkmcnt(4)
  v_mfma_f32_16x16x32_bf16 v[0:3], v[228:231], v[16:19], v[0:3]
  ds_read_b128 v[16:19], v27 offset:512
  s_waitcnt lgkmcnt(4)
  v_mfma_f32_16x16x32_bf16 v[0:3], v[232:235], v[20:23], v[0:3]
  ds_read_b128 v[20:23], v27 offset:576
  s_waitcnt lgkmcnt(4)
  v_mfma_f32_16x16x32_bf16 v[0:3], v[236:239], v[4:7], v[0:3]
  s_waitcnt lgkmcnt(3)
  v_mfma_f32_16x16x32_bf16 v[0:3], v[240:243], v[8:11], v[0:3]
  s_waitcnt lgkmcnt(2)
  v_mfma_f32_16x16x32_bf16 v[0:3], v[244:247], v[12:15], v[0:3]
  s_waitcnt lgkmcnt(1)
  v_mfma_f32_16x16x32_bf16 v[0:3], v[248:251], v[16:19], v[0:3]
  s_waitcnt lgkmcnt(0)
  v_mfma_f32_16x16x32_bf16 v[0:3], v[252:255], v[20:23], v[0:3]
  s_nop 7
  s_nop 0
  v_mov_b32_dpp v4, v0 row_ror:8 row_mask:0xf bank_mask:0xf
  v_mov_b32_dpp v5, v1 row_ror:8 row_mask:0xf bank_mask:0xf
  v_mov_b32_dpp v6, v2 row_ror:8 row_mask:0xf bank_mask:0xf
  v_mov_b32_dpp v7, v3 row_ror:8 row_mask:0xf bank_mask:0xf
  s_nop 0
  v_permlane32_swap_b32 v4, v8
  v_permlane32_swap_b32 v5, v9
  v_permlane32_swap_b32 v6, v10
  v_permlane32_swap_b32 v7, v11
  s_nop 0
  v_add_f32 v0, v0, v8
  v_add_f32 v1, v1, v9
  v_add_f32 v2, v2, v10
  v_add_f32 v3, v3, v11
  v_cvt_pk_bf16_f32 v4, v0, v1
  v_cvt_pk_bf16_f32 v5, v2, v3
  v_min_u32 v4, 0xfffffffe, v4
  v_min_u32 v5, 0xfffffffe, v5
  s_mov_b32 exec_lo, 0x00ff00ff
  s_mov_b32 exec_hi, 0
  s_cmp_eq_u32 s51, 0
  s_cbranch_scc1 SL_53
  buffer_store_dwordx2 v[4:5], v29, s[24:27], s76 offen
  s_branch SE_54
SL_53:
  buffer_store_dwordx2 v[4:5], v29, s[24:27], s76 offen sc1
SE_54:
  s_mov_b64 exec, -1
C_qp:
  s_mov_b32 s52, 983040
  v_mbcnt_lo_u32_b32 v30, -1, 0
  v_mbcnt_hi_u32_b32 v30, -1, v30
  s_cmp_lg_u32 s48, 0
  s_cbranch_scc1 QW_55
  v_lshlrev_b32 v29, 7, v30
  v_lshlrev_b32 v28, 4, v30
  s_lshl_b32 s56, s46, 11
  s_lshl_b32 s57, s47, 4
  s_add_u32 s56, s56, s57
  s_add_u32 s59, s56, 1572864
  s_mov_b64 exec, 0xffff
P_56:
  buffer_load_dwordx4 v[16:19], v29, s[24:27], s59 offen sc1
  s_waitcnt vmcnt(0)
  v_max3_u32 v31, v16, v17, v18
  v_max_u32 v31, v31, v19
  v_cmp_eq_u32 vcc, -1, v31
  s_cmp_eq_u64 vcc, 0
  s_cbranch_scc1 PD_57
  s_add_u32 s53, s53, 1
  s_cmp_lt_u32 s53, 400000
  s_cbranch_scc1 P_56
PD_57:
  ds_write_b128 v28, v[16:19] offset:14848
  s_mov_b64 exec, -1
  s_waitcnt lgkmcnt(0)
QW_55:
  v_mbcnt_lo_u32_b32 v26, -1, 0
  v_mbcnt_hi_u32_b32 v26, -1, v26
  v_lshrrev_b32 v30, 5, v26
  v_lshlrev_b32 v30, 3, v30
  v_bfe_u32 v27, v26, 1, 1
  v_lshl_add_u32 v30, v27, 2, v30
  v_bfe_u32 v27, v26, 4, 1
  v_lshl_add_u32 v30, v27, 1, v30
  v_and_b32 v27, 1, v26
  v_lshlrev_b32 v27, 2, v27
  v_lshl_add_u32 v30, v30, 4, v27
  v_add_u32 v30, 14848, v30
  s_barrier
  ds_read2_b32 v[0:1], v30 offset0:0 offset1:2
  ds_read2_b32 v[2:3], v30 offset0:4 offset1:6
  s_waitcnt vmcnt(0)
  s_branch L_att
L_fin:
L_end:
  s_endpgm
.section .rodata,"a"
.p2align 6
.amdhsa_kernel interleave_layers__sliding_block_cached__mixer_channel_mlp__decode_kernel
  .amdhsa_next_free_vgpr 256
  .amdhsa_next_free_sgpr 102
  .amdhsa_accum_offset 256
  .amdhsa_group_segment_fixed_size 0
  .amdhsa_kernarg_size 104
  .amdhsa_user_sgpr_count 2
  .amdhsa_user_sgpr_kernarg_segment_ptr 1
  .amdhsa_system_sgpr_workgroup_id_x 1
  .amdhsa_float_denorm_mode_32 3
.end_amdhsa_kernel
```
